```python
import torch

def _softmax(x, axis=-1):
    return torch.softmax(x, dim=axis)
def _gelu(x):
    return torch.nn.functional.gelu(x, approximate="tanh")
def _silu(x):
    return torch.nn.functional.silu(x)
def _sigmoid(x):
    return torch.sigmoid(x)
def _layernorm(x, axis=-1, eps=1e-5):
    m = x.mean(dim=axis, keepdim=True)
    v = x.var(dim=axis, keepdim=True, unbiased=False)
    return (x - m) / torch.sqrt(v + eps)
def _scatter_add(tgt, idx, src, axis=0):
    return tgt.clone().index_add_(axis, idx, src)
def _segment_sum(src, seg, n):
    out = torch.zeros((n,) + src.shape[1:], dtype=src.dtype)
    return out.index_add_(0, seg, src)
def _pad(x, pw):
    flat = tuple(v for pair in reversed(pw) for v in pair)
    return torch.nn.functional.pad(x, flat)

kernel_name = 'parallel_sum__linear_attn_block__mixer_channel_mlp__prompt'

def setup_inputs():

    _w = (lambda a: (lambda t: t.to(torch.bfloat16) if t.is_floating_point() else t)(torch.as_tensor(a)))
    def _A_setup():
        B, S, D = 1, 2048, 448
        return {
            "x": _w((lambda *s: torch.randn(*s, dtype=torch.bfloat16) * 0.05)(B, S, D)),
            "wqkv": _w((lambda *s: torch.randn(*s, dtype=torch.bfloat16) * 0.1)(D, 3 * D)),
            "wo": _w((lambda *s: torch.randn(*s, dtype=torch.bfloat16) * 0.05)(D, D)),
        }
    _A_in = _A_setup()

    def _B_setup():
        B, S, D, F = 1, 2048, 448, 1792
        return {
            "x": _w((lambda *s: torch.randn(*s, dtype=torch.bfloat16) * 0.05)(B, S, D)),
            "w1": _w((lambda *s: torch.randn(*s, dtype=torch.bfloat16) * 1.6)(D, F) * (D ** -0.5)),
            "b1": _w((lambda *s: torch.randn(*s, dtype=torch.bfloat16) * 0.4)(F)),
            "w2": _w((lambda *s: torch.randn(*s, dtype=torch.bfloat16) * 0.05)(F, D) * (F ** -0.5)),
            "b2": _w((lambda *s: torch.randn(*s, dtype=torch.bfloat16) * 0.05)(D)),
        }
    _B_in = _B_setup()

    return {
        "A_x": _A_in["x"],
        "A_wqkv": _A_in["wqkv"],
        "A_wo": _A_in["wo"],
        "B_x": _B_in["x"],
        "B_w1": _B_in["w1"],
        "B_b1": _B_in["b1"],
        "B_w2": _B_in["w2"],
        "B_b2": _B_in["b2"],
    }

def reference(A_x, A_wqkv, A_wo, B_x, B_w1, B_b1, B_w2, B_b2):
    def _A_ref(x, wqkv, wo):
        B, S, D = x.shape
        H = 16; Dh = D // H
        qkv = (lambda x, *d: x.permute(*d))((x @ wqkv).reshape(B, S, 3, H, Dh), 2, 0, 3, 1, 4)
        q, k, v = qkv[0], qkv[1], qkv[2]
        phi = lambda t: torch.where(t > 0, t + 1, torch.exp(t)) + 1e-6
        pq, pk = phi(q), phi(k)
        kv = torch.einsum("bhsd,bhse->bhde", pk, v)
        z = torch.einsum("bhsd->bhd", pk)
        num = torch.einsum("bhqd,bhde->bhqe", pq, kv)
        den = torch.einsum("bhqd,bhd->bhq", pq, z)[..., None] + 1e-6
        o = num / den
        return (lambda x, *d: x.permute(*d))(o, 0, 2, 1, 3).reshape(B, S, D) @ wo

    def _B_ref(x, w1, b1, w2, b2):
        y = _layernorm(x, axis=-1)
        h = _gelu(torch.einsum("bsd,df->bsf", y, w1) + b1)
        return torch.einsum("bsf,fd->bsd", h, w2) + b2

    x = A_x
    xn = _layernorm(x, axis=-1)
    return x + _A_ref(xn, A_wqkv, A_wo) + _B_ref(xn, B_w1, B_b1, B_w2, B_b2)
```

```asm
; @launch grid=(256,1,1) block=(512,1,1) lds=163840
.amdgcn_target "amdgcn-amd-amdhsa--gfx950"
.text
.globl parallel_sum__linear_attn_block__mixer_channel_mlp__prompt_kernel
.p2align 8
.type parallel_sum__linear_attn_block__mixer_channel_mlp__prompt_kernel,@function
parallel_sum__linear_attn_block__mixer_channel_mlp__prompt_kernel:
    s_cmp_ge_u32 s2, 256
    s_cbranch_scc1 L_EXIT
    s_load_dwordx2 s[40:41], s[0:1], 0
    v_lshrrev_b32 v2, 6, v0
    v_and_b32 v1, 63, v0
    v_readfirstlane_b32 s68, v2
    s_load_dwordx16 s[16:31], s[0:1], 0
    s_setprio 3
    s_lshr_b32 s15, s2, 6
    s_and_b32 s69, s2, 6
    s_lshl_b32 s69, s69, 1
    s_add_u32 s69, s69, s15
    s_bfe_u32 s74, s2, 0x30003
    v_lshrrev_b32 v2, 3, v1
    v_and_b32 v3, 7, v1
    v_mul_u32_u24 v6, 896, v2
    v_lshl_add_u32 v6, v3, 4, v6
    s_add_u32 s80, s68, s74
    s_and_b32 s80, s80, 7
    s_lshl_b32 s100, s69, 3
    s_add_u32 s100, s100, s80
    s_mul_i32 s100, s100, 14336
    s_add_u32 s101, s100, 7168
    s_mov_b32 s42, 1835008
    s_mov_b32 s43, 0x20000
    s_cmp_lt_u32 s68, 4
    s_cbranch_scc0 L_X1
    s_setprio 2
    s_waitcnt lgkmcnt(0)
    buffer_load_dwordx4 v[64:67], v6, s[40:43], s100 offen offset:0
    buffer_load_dwordx4 v[68:71], v6, s[40:43], s101 offen offset:0
    buffer_load_dwordx4 v[72:75], v6, s[40:43], s100 offen offset:128
    buffer_load_dwordx4 v[76:79], v6, s[40:43], s101 offen offset:128
    buffer_load_dwordx4 v[80:83], v6, s[40:43], s100 offen offset:256
    buffer_load_dwordx4 v[84:87], v6, s[40:43], s101 offen offset:256
    buffer_load_dwordx4 v[88:91], v6, s[40:43], s100 offen offset:384
    buffer_load_dwordx4 v[92:95], v6, s[40:43], s101 offen offset:384
    buffer_load_dwordx4 v[96:99], v6, s[40:43], s100 offen offset:512
    buffer_load_dwordx4 v[100:103], v6, s[40:43], s101 offen offset:512
    buffer_load_dwordx4 v[104:107], v6, s[40:43], s100 offen offset:640
    buffer_load_dwordx4 v[108:111], v6, s[40:43], s101 offen offset:640
    buffer_load_dwordx4 v[112:115], v6, s[40:43], s100 offen offset:768
    buffer_load_dwordx4 v[116:119], v6, s[40:43], s101 offen offset:768
    s_setprio 0
    s_branch L_X2
L_X1:
    s_cmp_lg_u32 s68, 4
    s_cbranch_scc1 L_X5
    s_getpc_b64 s[96:97]
    s_lshr_b32 s3, s2, 3
    s_lshl_b32 s3, s3, 10
    v_lshlrev_b32 v4, 7, v1
    v_add_u32 v4, s3, v4
    s_mov_b64 exec, 0xff
    global_load_dword v120, v4, s[96:97]
    s_mov_b64 exec, -1
    s_setprio 2
    s_branch L_X2
L_X5:
    s_setprio 2
L_X2:
    s_load_dwordx4 s[32:35], s[0:1], 64
    s_load_dwordx2 s[48:49], s[0:1], 80
    s_and_b32 s73, s2, 7
    s_lshr_b32 s71, s74, 2
    s_and_b32 s70, s73, 1
    s_lshl_b32 s70, s70, 2
    s_and_b32 s3, s74, 3
    s_add_u32 s70, s70, s3
    s_lshl_b32 s92, s73, 2
    s_add_u32 s92, s92, s15
    s_cmp_lg_u32 s74, 5
    s_cselect_b32 s90, 1, 0
    s_cmp_gt_u32 s74, 5
    s_cselect_b32 s3, 1, 0
    s_sub_u32 s91, s74, s3
    s_lshr_b32 s75, s68, 2
    s_and_b32 s76, s68, 3
    v_lshlrev_b32 v13, 4, v1
    v_mov_b32 v23, 0
    s_lshl_b32 s84, s70, 1
    s_add_u32 s84, s84, s75
    s_mov_b32 s50, 16777216
    s_mov_b32 s51, 0x20000
    s_mov_b32 s67, 0x20000
    v_mov_b32 v24, 0
    v_mov_b32 v25, 0
    v_mov_b32 v26, 0
    v_mov_b32 v27, 0
    s_waitcnt lgkmcnt(0)
    s_mov_b64 s[52:53], s[34:35]
    s_mov_b32 s54, 256
    s_mov_b32 s55, 0x20000
    s_mov_b64 s[56:57], s[28:29]
    s_mov_b32 s58, 1605632
    s_mov_b32 s59, 0x20000
    s_mov_b64 s[60:61], s[20:21]
    s_mov_b32 s62, 401408
    s_mov_b32 s63, 0x20000
    s_add_u32 s93, s76, s15
    s_and_b32 s93, s93, 3
    s_cmp_eq_u32 s71, 0
    s_cselect_b64 s[44:45], s[18:19], s[24:25]
    s_mov_b32 s47, 0x20000
    s_mov_b32 s72, 3584
    s_cselect_b32 s72, 2688, s72
    s_mul_i32 s46, s72, 448
    s_cselect_b64 s[98:99], 0, -1
    s_mul_i32 s73, s93, s72
    s_cbranch_scc0 L_PM
    s_lshl_b32 s73, s73, 3
    s_mul_i32 s3, s70, 112
    s_add_u32 s73, s73, s3
    s_add_u32 s4, s73, 896
    s_add_u32 s5, s73, 603008
    s_add_u32 s6, s73, 1792
    s_add_u32 s7, s73, 603904
    s_mov_b32 s8, s73
    s_add_u32 s9, s73, 602112
    s_mul_i32 s74, s75, 56
    s_branch L_PJ
L_PM:
    s_lshl_b32 s73, s73, 3
    s_lshl_b32 s3, s70, 7
    s_add_u32 s4, s73, s3
    s_add_u32 s5, s4, 802816
    s_add_u32 s6, s4, 1024
    s_add_u32 s7, s4, 803840
    s_add_u32 s8, s4, 2048
    s_add_u32 s9, s4, 804864
    s_lshl_b32 s74, s75, 6
    s_add_u32 s94, s74, s3
L_PJ:
    s_lshl_b32 s87, s72, 5
    v_lshrrev_b32 v4, 2, v1
    v_and_b32 v4, 4, v4
    v_xor_b32 v4, v4, v3
    v_mul_lo_u32 v5, v2, s72
    v_lshl_add_u32 v7, v4, 4, v5
    v_mul_u32_u24 v121, 896, v2
    v_lshl_add_u32 v121, v4, 4, v121
    s_lshl_b32 s3, s91, 7
    v_add_u32 v121, s3, v121
    v_xor_b32 v4, v2, v3
    v_lshlrev_b32 v4, 4, v4
    v_lshl_add_u32 v9, v3, 9, v4
    s_lshr_b32 s3, s80, 1
    s_lshl_b32 s3, s3, 14
    s_and_b32 s73, s80, 1
    s_lshl_b32 s73, s73, 8
    s_add_u32 s3, s3, s73
    s_add_u32 s3, s3, 86016
    v_add_u32 v9, s3, v9
    v_lshrrev_b32 v4, 5, v1
    v_and_b32 v5, 31, v1
    v_xor_b32 v5, v5, v4
    v_lshlrev_b32 v5, 4, v5
    v_lshl_add_u32 v5, v4, 9, v5
    s_lshl_b32 s3, s76, 14
    s_add_u32 s3, s3, 86016
    v_xor_b32 v16, 0, v5
    v_add_u32 v16, s3, v16
    v_xor_b32 v17, 32, v5
    v_add_u32 v17, s3, v17
    v_xor_b32 v18, 64, v5
    v_add_u32 v18, s3, v18
    v_xor_b32 v19, 96, v5
    v_add_u32 v19, s3, v19
    v_and_b32 v2, 3, v1
    v_lshlrev_b32 v2, 3, v2
    v_and_b32 v3, 16, v1
    v_lshl_add_u32 v2, v3, 1, v2
    v_add_u32 v2, s74, v2
    v_and_b32 v3, 8, v1
    v_lshlrev_b32 v3, 3, v3
    v_xor_b32 v2, v2, v3
    v_and_b32 v3, 12, v1
    v_lshl_add_u32 v2, v3, 5, v2
    v_lshl_add_u32 v10, v4, 10, v2
    s_mov_b32 s77, 0xffff0000
    s_mov_b32 s78, 0x3f803f80
    s_mov_b32 s79, 0x409d30fc
    v_mov_b32 v14, 0x3eeff558
    v_lshlrev_b32 v15, 4, v4
    v_add_u32 v15, 151552, v15
    s_lshl_b32 s81, s69, 2
    s_add_u32 s81, s81, s76
    s_lshl_b32 s11, s69, 1
    s_lshl_b32 s11, s11, 12
    s_lshl_b32 s3, s71, 3
    s_add_u32 s3, s3, s70
    s_lshl_b32 s3, s3, 9
    s_add_u32 s11, s11, s3
    s_add_u32 s11, s11, 10616832
    s_mul_i32 s81, s81, 147456
    s_lshl_b32 s93, s93, 10
    s_mov_b32 m0, s93
    s_add_u32 s83, s68, s91
    s_and_b32 s83, s83, 7
    s_lshr_b32 s13, s92, 1
    s_lshl_b32 s13, s13, 13
    s_add_u32 s13, s13, 10616832
    s_mul_i32 s95, s92, 288
    s_add_u32 s95, s95, s83
    s_lshl_b32 s95, s95, 10
    s_lshl_b32 s12, s70, 9
    s_add_u32 s12, s12, 10616832
    v_add_u32 v11, 0, v10
    v_add_u32 v12, 28672, v10
    s_cmp_eq_u32 s75, 0
    s_cbranch_scc1 L_X3
    s_mov_b64 s[64:65], s[26:27]
    s_mov_b32 s66, 3584
    s_cmp_eq_u32 s71, 0
    s_cbranch_scc0 L_ZM
    s_cmp_lg_u32 s69, 0
    s_cbranch_scc1 L_X4
    s_lshl_b32 s3, s70, 13
    s_lshl_b32 s73, s76, 11
    s_add_u32 s3, s3, s73
    s_add_u32 s3, s3, 10485760
    buffer_store_dwordx4 v[24:27], v13, s[48:51], s3 offen sc1
    buffer_store_dwordx4 v[24:27], v13, s[48:51], s3 offen offset:1024 sc1
    s_nop 0
    s_branch L_X4
L_ZM:
    s_or_b32 s3, s70, 0
    s_cmp_lg_u32 s3, 0
    s_cbranch_scc1 L_X4
    s_lshl_b32 s3, s69, 13
    s_lshl_b32 s73, s76, 11
    s_add_u32 s3, s3, s73
    s_add_u32 s3, s3, 10616832
    buffer_store_dwordx4 v[24:27], v13, s[48:51], s3 offen sc1
    buffer_store_dwordx4 v[24:27], v13, s[48:51], s3 offen offset:1024 sc1
L_X4:
    buffer_load_dwordx4 v[64:67], v6, s[40:43], s100 offen offset:0
    buffer_load_dwordx4 v[68:71], v6, s[40:43], s101 offen offset:0
    buffer_load_dwordx4 v[72:75], v6, s[40:43], s100 offen offset:128
    buffer_load_dwordx4 v[76:79], v6, s[40:43], s101 offen offset:128
    buffer_load_dwordx4 v[80:83], v6, s[40:43], s100 offen offset:256
    buffer_load_dwordx4 v[84:87], v6, s[40:43], s101 offen offset:256
    buffer_load_dwordx4 v[88:91], v6, s[40:43], s100 offen offset:384
    buffer_load_dwordx4 v[92:95], v6, s[40:43], s101 offen offset:384
    buffer_load_dwordx4 v[96:99], v6, s[40:43], s100 offen offset:512
    buffer_load_dwordx4 v[100:103], v6, s[40:43], s101 offen offset:512
    buffer_load_dwordx4 v[104:107], v6, s[40:43], s100 offen offset:640
    buffer_load_dwordx4 v[108:111], v6, s[40:43], s101 offen offset:640
    buffer_load_dwordx4 v[112:115], v6, s[40:43], s100 offen offset:768
    buffer_load_dwordx4 v[116:119], v6, s[40:43], s101 offen offset:768
    s_lshl_b32 s3, s76, 10
    s_mul_i32 s66, s66, s71
    buffer_load_dwordx4 v[48:51], v13, s[64:67], s3 offen
    s_setprio 1
L_X3:
    s_waitcnt vmcnt(12)
    v_dot2c_f32_bf16 v24, s78, v64
    v_dot2c_f32_bf16 v26, v64, v64
    v_dot2c_f32_bf16 v25, s78, v68
    v_dot2c_f32_bf16 v27, v68, v68
    v_dot2c_f32_bf16 v24, s78, v65
    v_dot2c_f32_bf16 v26, v65, v65
    v_dot2c_f32_bf16 v25, s78, v69
    v_dot2c_f32_bf16 v27, v69, v69
    v_dot2c_f32_bf16 v24, s78, v66
    v_dot2c_f32_bf16 v26, v66, v66
    v_dot2c_f32_bf16 v25, s78, v70
    v_dot2c_f32_bf16 v27, v70, v70
    v_dot2c_f32_bf16 v24, s78, v67
    v_dot2c_f32_bf16 v26, v67, v67
    v_dot2c_f32_bf16 v25, s78, v71
    v_dot2c_f32_bf16 v27, v71, v71
    s_waitcnt vmcnt(10)
    v_dot2c_f32_bf16 v24, s78, v72
    v_dot2c_f32_bf16 v26, v72, v72
    v_dot2c_f32_bf16 v25, s78, v76
    v_dot2c_f32_bf16 v27, v76, v76
    v_dot2c_f32_bf16 v24, s78, v73
    v_dot2c_f32_bf16 v26, v73, v73
    v_dot2c_f32_bf16 v25, s78, v77
    v_dot2c_f32_bf16 v27, v77, v77
    v_dot2c_f32_bf16 v24, s78, v74
    v_dot2c_f32_bf16 v26, v74, v74
    v_dot2c_f32_bf16 v25, s78, v78
    v_dot2c_f32_bf16 v27, v78, v78
    v_dot2c_f32_bf16 v24, s78, v75
    v_dot2c_f32_bf16 v26, v75, v75
    v_dot2c_f32_bf16 v25, s78, v79
    v_dot2c_f32_bf16 v27, v79, v79
    s_waitcnt vmcnt(8)
    v_dot2c_f32_bf16 v24, s78, v80
    v_dot2c_f32_bf16 v26, v80, v80
    v_dot2c_f32_bf16 v25, s78, v84
    v_dot2c_f32_bf16 v27, v84, v84
    v_dot2c_f32_bf16 v24, s78, v81
    v_dot2c_f32_bf16 v26, v81, v81
    v_dot2c_f32_bf16 v25, s78, v85
    v_dot2c_f32_bf16 v27, v85, v85
    v_dot2c_f32_bf16 v24, s78, v82
    v_dot2c_f32_bf16 v26, v82, v82
    v_dot2c_f32_bf16 v25, s78, v86
    v_dot2c_f32_bf16 v27, v86, v86
    v_dot2c_f32_bf16 v24, s78, v83
    v_dot2c_f32_bf16 v26, v83, v83
    v_dot2c_f32_bf16 v25, s78, v87
    v_dot2c_f32_bf16 v27, v87, v87
    s_waitcnt vmcnt(6)
    v_dot2c_f32_bf16 v24, s78, v88
    v_dot2c_f32_bf16 v26, v88, v88
    v_dot2c_f32_bf16 v25, s78, v92
    v_dot2c_f32_bf16 v27, v92, v92
    v_dot2c_f32_bf16 v24, s78, v89
    v_dot2c_f32_bf16 v26, v89, v89
    v_dot2c_f32_bf16 v25, s78, v93
    v_dot2c_f32_bf16 v27, v93, v93
    v_dot2c_f32_bf16 v24, s78, v90
    v_dot2c_f32_bf16 v26, v90, v90
    v_dot2c_f32_bf16 v25, s78, v94
    v_dot2c_f32_bf16 v27, v94, v94
    v_dot2c_f32_bf16 v24, s78, v91
    v_dot2c_f32_bf16 v26, v91, v91
    v_dot2c_f32_bf16 v25, s78, v95
    v_dot2c_f32_bf16 v27, v95, v95
    s_waitcnt vmcnt(4)
    v_dot2c_f32_bf16 v24, s78, v96
    v_dot2c_f32_bf16 v26, v96, v96
    v_dot2c_f32_bf16 v25, s78, v100
    v_dot2c_f32_bf16 v27, v100, v100
    v_dot2c_f32_bf16 v24, s78, v97
    v_dot2c_f32_bf16 v26, v97, v97
    v_dot2c_f32_bf16 v25, s78, v101
    v_dot2c_f32_bf16 v27, v101, v101
    v_dot2c_f32_bf16 v24, s78, v98
    v_dot2c_f32_bf16 v26, v98, v98
    v_dot2c_f32_bf16 v25, s78, v102
    v_dot2c_f32_bf16 v27, v102, v102
    v_dot2c_f32_bf16 v24, s78, v99
    v_dot2c_f32_bf16 v26, v99, v99
    v_dot2c_f32_bf16 v25, s78, v103
    v_dot2c_f32_bf16 v27, v103, v103
    s_waitcnt vmcnt(2)
    v_dot2c_f32_bf16 v24, s78, v104
    v_dot2c_f32_bf16 v26, v104, v104
    v_dot2c_f32_bf16 v25, s78, v108
    v_dot2c_f32_bf16 v27, v108, v108
    v_dot2c_f32_bf16 v24, s78, v105
    v_dot2c_f32_bf16 v26, v105, v105
    v_dot2c_f32_bf16 v25, s78, v109
    v_dot2c_f32_bf16 v27, v109, v109
    v_dot2c_f32_bf16 v24, s78, v106
    v_dot2c_f32_bf16 v26, v106, v106
    v_dot2c_f32_bf16 v25, s78, v110
    v_dot2c_f32_bf16 v27, v110, v110
    v_dot2c_f32_bf16 v24, s78, v107
    v_dot2c_f32_bf16 v26, v107, v107
    v_dot2c_f32_bf16 v25, s78, v111
    v_dot2c_f32_bf16 v27, v111, v111
    s_waitcnt vmcnt(1)
    s_cmp_lg_u32 s75, 0
    s_cbranch_scc1 L_W6
    s_waitcnt vmcnt(0)
L_W6:
    v_dot2c_f32_bf16 v24, s78, v112
    v_dot2c_f32_bf16 v26, v112, v112
    v_dot2c_f32_bf16 v25, s78, v116
    v_dot2c_f32_bf16 v27, v116, v116
    v_dot2c_f32_bf16 v24, s78, v113
    v_dot2c_f32_bf16 v26, v113, v113
    v_dot2c_f32_bf16 v25, s78, v117
    v_dot2c_f32_bf16 v27, v117, v117
    v_dot2c_f32_bf16 v24, s78, v114
    v_dot2c_f32_bf16 v26, v114, v114
    v_dot2c_f32_bf16 v25, s78, v118
    v_dot2c_f32_bf16 v27, v118, v118
    v_dot2c_f32_bf16 v24, s78, v115
    v_dot2c_f32_bf16 v26, v115, v115
    v_dot2c_f32_bf16 v25, s78, v119
    v_dot2c_f32_bf16 v27, v119, v119
    v_mov_b32 v6, v121
    v_add_f32_dpp v24, v24, v24 quad_perm:[1,0,3,2] row_mask:0xf bank_mask:0xf
    v_add_f32_dpp v25, v25, v25 quad_perm:[1,0,3,2] row_mask:0xf bank_mask:0xf
    v_add_f32_dpp v26, v26, v26 quad_perm:[1,0,3,2] row_mask:0xf bank_mask:0xf
    v_add_f32_dpp v27, v27, v27 quad_perm:[1,0,3,2] row_mask:0xf bank_mask:0xf
    v_add_f32_dpp v24, v24, v24 quad_perm:[2,3,0,1] row_mask:0xf bank_mask:0xf
    v_add_f32_dpp v25, v25, v25 quad_perm:[2,3,0,1] row_mask:0xf bank_mask:0xf
    v_add_f32_dpp v26, v26, v26 quad_perm:[2,3,0,1] row_mask:0xf bank_mask:0xf
    v_add_f32_dpp v27, v27, v27 quad_perm:[2,3,0,1] row_mask:0xf bank_mask:0xf
    v_add_f32_dpp v24, v24, v24 row_half_mirror row_mask:0xf bank_mask:0xf
    v_add_f32_dpp v25, v25, v25 row_half_mirror row_mask:0xf bank_mask:0xf
    v_add_f32_dpp v26, v26, v26 row_half_mirror row_mask:0xf bank_mask:0xf
    v_add_f32_dpp v27, v27, v27 row_half_mirror row_mask:0xf bank_mask:0xf
    v_mul_f32 v24, 0x3b124925, v24
    v_mul_f32 v25, 0x3b124925, v25
    v_mul_f32 v26, 0x3b124925, v26
    v_mul_f32 v27, 0x3b124925, v27
    v_fma_f32 v26, -v24, v24, v26
    v_fma_f32 v27, -v25, v25, v27
    v_max_f32 v26, 0, v26
    v_max_f32 v27, 0, v27
    v_add_f32 v28, 0x3727c5ac, v26
    v_add_f32 v29, 0x3727c5ac, v27
    v_rsq_f32 v28, v28
    v_rsq_f32 v29, v29
    v_mul_f32 v26, v26, v28
    v_mul_f32 v27, v27, v29
    v_mul_f32 v26, v26, v28
    v_mul_f32 v27, v27, v29
    v_add_f32 v26, 0x3727c5ac, v26
    v_add_f32 v27, 0x3727c5ac, v27
    v_rsq_f32 v26, v26
    v_rsq_f32 v27, v27
    v_mul_f32 v26, v14, v26
    v_mul_f32 v27, v14, v27
    v_cndmask_b32 v26, 1.0, v26, s[98:99]
    v_cndmask_b32 v27, 1.0, v27, s[98:99]
    v_mul_f32 v30, v29, v27
    v_mul_f32 v28, v28, v26
    v_mul_f32 v29, -v24, v28
    v_mul_f32 v31, -v25, v30
    v_lshlrev_b32 v32, 16, v64
    v_and_b32 v33, s77, v64
    v_lshlrev_b32 v34, 16, v65
    v_and_b32 v35, s77, v65
    v_lshlrev_b32 v36, 16, v66
    v_and_b32 v37, s77, v66
    v_lshlrev_b32 v38, 16, v67
    v_and_b32 v39, s77, v67
    v_pk_fma_f32 v[32:33], v[32:33], v[28:29], v[28:29] op_sel:[0,0,1] op_sel_hi:[1,0,1]
    v_pk_fma_f32 v[34:35], v[34:35], v[28:29], v[28:29] op_sel:[0,0,1] op_sel_hi:[1,0,1]
    v_pk_fma_f32 v[36:37], v[36:37], v[28:29], v[28:29] op_sel:[0,0,1] op_sel_hi:[1,0,1]
    v_pk_fma_f32 v[38:39], v[38:39], v[28:29], v[28:29] op_sel:[0,0,1] op_sel_hi:[1,0,1]
    v_cvt_pk_bf16_f32 v64, v32, v33
    v_cvt_pk_bf16_f32 v65, v34, v35
    v_cvt_pk_bf16_f32 v66, v36, v37
    v_cvt_pk_bf16_f32 v67, v38, v39
    ds_write_b128 v9, v[64:67] offset:0
    v_lshlrev_b32 v40, 16, v68
    v_and_b32 v41, s77, v68
    v_lshlrev_b32 v42, 16, v69
    v_and_b32 v43, s77, v69
    v_lshlrev_b32 v44, 16, v70
    v_and_b32 v45, s77, v70
    v_lshlrev_b32 v46, 16, v71
    v_and_b32 v47, s77, v71
    v_pk_fma_f32 v[40:41], v[40:41], v[30:31], v[30:31] op_sel:[0,0,1] op_sel_hi:[1,0,1]
    v_pk_fma_f32 v[42:43], v[42:43], v[30:31], v[30:31] op_sel:[0,0,1] op_sel_hi:[1,0,1]
    v_pk_fma_f32 v[44:45], v[44:45], v[30:31], v[30:31] op_sel:[0,0,1] op_sel_hi:[1,0,1]
    v_pk_fma_f32 v[46:47], v[46:47], v[30:31], v[30:31] op_sel:[0,0,1] op_sel_hi:[1,0,1]
    v_cvt_pk_bf16_f32 v68, v40, v41
    v_cvt_pk_bf16_f32 v69, v42, v43
    v_cvt_pk_bf16_f32 v70, v44, v45
    v_cvt_pk_bf16_f32 v71, v46, v47
    ds_write_b128 v9, v[68:71] offset:128
    v_lshlrev_b32 v32, 16, v72
    v_and_b32 v33, s77, v72
    v_lshlrev_b32 v34, 16, v73
    v_and_b32 v35, s77, v73
    v_lshlrev_b32 v36, 16, v74
    v_and_b32 v37, s77, v74
    v_lshlrev_b32 v38, 16, v75
    v_and_b32 v39, s77, v75
    v_pk_fma_f32 v[32:33], v[32:33], v[28:29], v[28:29] op_sel:[0,0,1] op_sel_hi:[1,0,1]
    v_pk_fma_f32 v[34:35], v[34:35], v[28:29], v[28:29] op_sel:[0,0,1] op_sel_hi:[1,0,1]
    v_pk_fma_f32 v[36:37], v[36:37], v[28:29], v[28:29] op_sel:[0,0,1] op_sel_hi:[1,0,1]
    v_pk_fma_f32 v[38:39], v[38:39], v[28:29], v[28:29] op_sel:[0,0,1] op_sel_hi:[1,0,1]
    v_cvt_pk_bf16_f32 v72, v32, v33
    v_cvt_pk_bf16_f32 v73, v34, v35
    v_cvt_pk_bf16_f32 v74, v36, v37
    v_cvt_pk_bf16_f32 v75, v38, v39
    ds_write_b128 v9, v[72:75] offset:4096
    v_lshlrev_b32 v40, 16, v76
    v_and_b32 v41, s77, v76
    v_lshlrev_b32 v42, 16, v77
    v_and_b32 v43, s77, v77
    v_lshlrev_b32 v44, 16, v78
    v_and_b32 v45, s77, v78
    v_lshlrev_b32 v46, 16, v79
    v_and_b32 v47, s77, v79
    v_pk_fma_f32 v[40:41], v[40:41], v[30:31], v[30:31] op_sel:[0,0,1] op_sel_hi:[1,0,1]
    v_pk_fma_f32 v[42:43], v[42:43], v[30:31], v[30:31] op_sel:[0,0,1] op_sel_hi:[1,0,1]
    v_pk_fma_f32 v[44:45], v[44:45], v[30:31], v[30:31] op_sel:[0,0,1] op_sel_hi:[1,0,1]
    v_pk_fma_f32 v[46:47], v[46:47], v[30:31], v[30:31] op_sel:[0,0,1] op_sel_hi:[1,0,1]
    v_cvt_pk_bf16_f32 v76, v40, v41
    v_cvt_pk_bf16_f32 v77, v42, v43
    v_cvt_pk_bf16_f32 v78, v44, v45
    v_cvt_pk_bf16_f32 v79, v46, v47
    ds_write_b128 v9, v[76:79] offset:4224
    s_cmp_eq_u32 s75, 0
    s_cbranch_scc0 L_C1
    buffer_load_dwordx4 v7, s[44:47], s4 offen lds
    s_add_u32 s4, s4, s87
    s_add_u32 m0, m0, 4096
    s_nop 0
    buffer_load_dwordx4 v7, s[44:47], s4 offen lds
    s_add_u32 s4, s4, s87
    s_add_u32 m0, m0, 4096
    s_nop 0
    buffer_load_dwordx4 v7, s[44:47], s4 offen lds
    s_add_u32 s4, s4, s87
    s_add_u32 m0, m0, 4096
    s_nop 0
    buffer_load_dwordx4 v7, s[44:47], s4 offen lds
    s_add_u32 s4, s4, s87
    s_add_u32 m0, m0, 4096
    s_cmp_lt_u32 s76, 2
    s_cselect_b64 s[64:65], s[24:25], s[18:19]
    s_cselect_b32 s73, 25, 19
    s_mov_b32 s66, 1204224
    s_cselect_b32 s66, 1605632, s66
    s_and_b32 s3, s68, 1
    s_lshl_b32 s85, s2, 1
    s_add_u32 s3, s3, s85
    s_mul_i32 s3, s3, s73
    s_lshl_b32 s3, s3, 7
    v_lshlrev_b32 v5, 7, v1
    s_bfm_b64 exec, s73, 0
    buffer_load_dword v124, v5, s[64:67], s3 offen
    s_mov_b64 exec, -1
    buffer_load_dwordx4 v7, s[44:47], s4 offen lds
    s_add_u32 s4, s4, s87
    s_add_u32 m0, m0, 4096
    s_nop 0
    buffer_load_dwordx4 v7, s[44:47], s4 offen lds
    s_add_u32 s4, s4, s87
    s_add_u32 m0, m0, 4096
    s_nop 0
    buffer_load_dwordx4 v7, s[44:47], s4 offen lds
    s_add_u32 s4, s4, s87
    s_add_u32 m0, m0, 4096
L_C1:
    v_lshlrev_b32 v32, 16, v80
    v_and_b32 v33, s77, v80
    v_lshlrev_b32 v34, 16, v81
    v_and_b32 v35, s77, v81
    v_lshlrev_b32 v36, 16, v82
    v_and_b32 v37, s77, v82
    v_lshlrev_b32 v38, 16, v83
    v_and_b32 v39, s77, v83
    v_pk_fma_f32 v[32:33], v[32:33], v[28:29], v[28:29] op_sel:[0,0,1] op_sel_hi:[1,0,1]
    v_pk_fma_f32 v[34:35], v[34:35], v[28:29], v[28:29] op_sel:[0,0,1] op_sel_hi:[1,0,1]
    v_pk_fma_f32 v[36:37], v[36:37], v[28:29], v[28:29] op_sel:[0,0,1] op_sel_hi:[1,0,1]
    v_pk_fma_f32 v[38:39], v[38:39], v[28:29], v[28:29] op_sel:[0,0,1] op_sel_hi:[1,0,1]
    v_cvt_pk_bf16_f32 v80, v32, v33
    v_cvt_pk_bf16_f32 v81, v34, v35
    v_cvt_pk_bf16_f32 v82, v36, v37
    v_cvt_pk_bf16_f32 v83, v38, v39
    ds_write_b128 v9, v[80:83] offset:8192
    v_lshlrev_b32 v40, 16, v84
    v_and_b32 v41, s77, v84
    v_lshlrev_b32 v42, 16, v85
    v_and_b32 v43, s77, v85
    v_lshlrev_b32 v44, 16, v86
    v_and_b32 v45, s77, v86
    v_lshlrev_b32 v46, 16, v87
    v_and_b32 v47, s77, v87
    v_pk_fma_f32 v[40:41], v[40:41], v[30:31], v[30:31] op_sel:[0,0,1] op_sel_hi:[1,0,1]
    v_pk_fma_f32 v[42:43], v[42:43], v[30:31], v[30:31] op_sel:[0,0,1] op_sel_hi:[1,0,1]
    v_pk_fma_f32 v[44:45], v[44:45], v[30:31], v[30:31] op_sel:[0,0,1] op_sel_hi:[1,0,1]
    v_pk_fma_f32 v[46:47], v[46:47], v[30:31], v[30:31] op_sel:[0,0,1] op_sel_hi:[1,0,1]
    v_cvt_pk_bf16_f32 v84, v40, v41
    v_cvt_pk_bf16_f32 v85, v42, v43
    v_cvt_pk_bf16_f32 v86, v44, v45
    v_cvt_pk_bf16_f32 v87, v46, v47
    ds_write_b128 v9, v[84:87] offset:8320
    v_lshlrev_b32 v32, 16, v88
    v_and_b32 v33, s77, v88
    v_lshlrev_b32 v34, 16, v89
    v_and_b32 v35, s77, v89
    v_lshlrev_b32 v36, 16, v90
    v_and_b32 v37, s77, v90
    v_lshlrev_b32 v38, 16, v91
    v_and_b32 v39, s77, v91
    v_pk_fma_f32 v[32:33], v[32:33], v[28:29], v[28:29] op_sel:[0,0,1] op_sel_hi:[1,0,1]
    v_pk_fma_f32 v[34:35], v[34:35], v[28:29], v[28:29] op_sel:[0,0,1] op_sel_hi:[1,0,1]
    v_pk_fma_f32 v[36:37], v[36:37], v[28:29], v[28:29] op_sel:[0,0,1] op_sel_hi:[1,0,1]
    v_pk_fma_f32 v[38:39], v[38:39], v[28:29], v[28:29] op_sel:[0,0,1] op_sel_hi:[1,0,1]
    v_cvt_pk_bf16_f32 v88, v32, v33
    v_cvt_pk_bf16_f32 v89, v34, v35
    v_cvt_pk_bf16_f32 v90, v36, v37
    v_cvt_pk_bf16_f32 v91, v38, v39
    ds_write_b128 v9, v[88:91] offset:12288
    v_lshlrev_b32 v40, 16, v92
    v_and_b32 v41, s77, v92
    v_lshlrev_b32 v42, 16, v93
    v_and_b32 v43, s77, v93
    v_lshlrev_b32 v44, 16, v94
    v_and_b32 v45, s77, v94
    v_lshlrev_b32 v46, 16, v95
    v_and_b32 v47, s77, v95
    v_pk_fma_f32 v[40:41], v[40:41], v[30:31], v[30:31] op_sel:[0,0,1] op_sel_hi:[1,0,1]
    v_pk_fma_f32 v[42:43], v[42:43], v[30:31], v[30:31] op_sel:[0,0,1] op_sel_hi:[1,0,1]
    v_pk_fma_f32 v[44:45], v[44:45], v[30:31], v[30:31] op_sel:[0,0,1] op_sel_hi:[1,0,1]
    v_pk_fma_f32 v[46:47], v[46:47], v[30:31], v[30:31] op_sel:[0,0,1] op_sel_hi:[1,0,1]
    v_cvt_pk_bf16_f32 v92, v40, v41
    v_cvt_pk_bf16_f32 v93, v42, v43
    v_cvt_pk_bf16_f32 v94, v44, v45
    v_cvt_pk_bf16_f32 v95, v46, v47
    ds_write_b128 v9, v[92:95] offset:12416
    s_cmp_eq_u32 s75, 0
    s_cbranch_scc0 L_C2
    s_add_u32 m0, s93, 28672
    s_nop 0
    buffer_load_dwordx4 v7, s[44:47], s5 offen lds
    s_add_u32 s5, s5, s87
    s_add_u32 m0, m0, 4096
    s_nop 0
    buffer_load_dwordx4 v7, s[44:47], s5 offen lds
    s_add_u32 s5, s5, s87
    s_add_u32 m0, m0, 4096
    s_nop 0
    buffer_load_dwordx4 v7, s[44:47], s5 offen lds
    s_add_u32 s5, s5, s87
    s_add_u32 m0, m0, 4096
    s_nop 0
    buffer_load_dwordx4 v7, s[44:47], s5 offen lds
    s_add_u32 s5, s5, s87
    s_add_u32 m0, m0, 4096
    s_nop 0
    buffer_load_dwordx4 v7, s[44:47], s5 offen lds
    s_add_u32 s5, s5, s87
    s_add_u32 m0, m0, 4096
    s_nop 0
    buffer_load_dwordx4 v7, s[44:47], s5 offen lds
    s_add_u32 s5, s5, s87
    s_add_u32 m0, m0, 4096
    s_nop 0
    buffer_load_dwordx4 v7, s[44:47], s5 offen lds
    s_add_u32 s5, s5, s87
    s_add_u32 m0, m0, 4096
L_C2:
    s_cmp_eq_u32 s75, 1
    s_cbranch_scc0 L_C3
    s_cmp_eq_u32 s71, 0
    s_cbranch_scc1 L_NB4
    s_waitcnt vmcnt(0)
    v_lshlrev_b32 v32, 16, v48
    v_and_b32 v33, s77, v48
    v_lshlrev_b32 v34, 16, v49
    v_and_b32 v35, s77, v49
    v_lshlrev_b32 v36, 16, v50
    v_and_b32 v37, s77, v50
    v_lshlrev_b32 v38, 16, v51
    v_and_b32 v39, s77, v51
    v_mul_f32 v32, v14, v32
    v_mul_f32 v33, v14, v33
    v_mul_f32 v34, v14, v34
    v_mul_f32 v35, v14, v35
    v_mul_f32 v36, v14, v36
    v_mul_f32 v37, v14, v37
    v_mul_f32 v38, v14, v38
    v_mul_f32 v39, v14, v39
    s_lshl_b32 s3, s76, 11
    s_add_u32 s3, s3, 151552
    v_lshlrev_b32 v2, 5, v1
    v_add_u32 v2, s3, v2
    ds_write_b128 v2, v[32:35]
    ds_write_b128 v2, v[36:39] offset:16
L_NB4:
    v_mov_b32 v2, 163776
    v_mov_b32 v4, 0
    v_mov_b32 v5, 0
    ds_write_b64 v2, v[4:5]
    ds_write_b64 v2, v[4:5] offset:8
    ds_write_b64 v2, v[4:5] offset:16
    ds_write_b64 v2, v[4:5] offset:24
    ds_write_b64 v2, v[4:5] offset:32
    ds_write_b64 v2, v[4:5] offset:40
    ds_write_b64 v2, v[4:5] offset:48
    ds_write_b64 v2, v[4:5] offset:56
    s_setprio 0
L_C3:
    s_waitcnt vmcnt(11) lgkmcnt(0)
    s_barrier
    s_cmp_eq_u32 s71, 0
    s_cbranch_scc1 L_ATT
    s_lshl_b32 s3, s94, 1
    v_add_u32 v2, s3, v15
    ds_read_b128 v[48:51], v2 offset:0
    ds_read_b128 v[52:55], v2 offset:32
    ds_read_b128 v[56:59], v2 offset:64
    ds_read_b128 v[60:63], v2 offset:96
    ds_read_b128 v[128:131], v16 offset:0
    ds_read_b64_tr_b16 v[64:65], v11 offset:0
    ds_read_b64_tr_b16 v[66:67], v11 offset:512
    ds_read_b128 v[132:135], v17 offset:1024
    ds_read_b64_tr_b16 v[68:69], v11 offset:2048
    ds_read_b64_tr_b16 v[70:71], v11 offset:2560
    ds_read_b128 v[136:139], v18 offset:2048
    ds_read_b64_tr_b16 v[72:73], v11 offset:4096
    ds_read_b64_tr_b16 v[74:75], v11 offset:4608
    ds_read_b128 v[140:143], v19 offset:3072
    s_mul_i32 s3, s75, s87
    s_lshl_b32 s3, s3, 2
    s_add_u32 s6, s6, s3
    s_lshl_b32 s3, s75, 14
    s_add_u32 s3, s3, 57344
    s_add_u32 m0, s93, s3
    s_xor_b32 s3, s68, 4
    s_or_b32 s3, s3, s70
    s_cmp_lg_u32 s3, 0
    s_cbranch_scc1 L_ZF5
    v_mov_b32 v4, 1
    s_lshl_b32 s3, s69, 2
    buffer_store_dword v4, v23, s[52:55], s3 offen offset:64 sc1
L_ZF5:
    v_lshlrev_b32 v80, 16, v96
    v_and_b32 v81, s77, v96
    v_lshlrev_b32 v82, 16, v97
    v_and_b32 v83, s77, v97
    v_lshlrev_b32 v84, 16, v98
    v_and_b32 v85, s77, v98
    v_lshlrev_b32 v86, 16, v99
    v_and_b32 v87, s77, v99
    v_fma_f32 v80, v80, v28, v29
    v_fma_f32 v81, v81, v28, v29
    v_fma_f32 v82, v82, v28, v29
    v_fma_f32 v83, v83, v28, v29
    ds_read_b64_tr_b16 v[76:77], v11 offset:6144
    ds_read_b64_tr_b16 v[78:79], v11 offset:6656
    ds_read_b128 v[144:147], v16 offset:4096
    ds_read_b128 v[148:151], v17 offset:5120
    ds_read_b128 v[152:155], v18 offset:6144
    s_waitcnt lgkmcnt(12)
    v_mfma_f32_32x32x16_bf16 v[32:47], v[64:67], v[128:131], v[48:63]
    v_fma_f32 v84, v84, v28, v29
    v_fma_f32 v85, v85, v28, v29
    v_fma_f32 v86, v86, v28, v29
    v_fma_f32 v87, v87, v28, v29
    v_cvt_pk_bf16_f32 v96, v80, v81
    v_cvt_pk_bf16_f32 v97, v82, v83
    v_cvt_pk_bf16_f32 v98, v84, v85
    v_cvt_pk_bf16_f32 v99, v86, v87
    ds_read_b64_tr_b16 v[64:65], v11 offset:8192
    ds_read_b64_tr_b16 v[66:67], v11 offset:8704
    ds_read_b128 v[156:159], v19 offset:7168
    ds_read_b128 v[160:163], v16 offset:8192
    ds_read_b128 v[164:167], v17 offset:9216
    s_waitcnt lgkmcnt(14)
    v_mfma_f32_32x32x16_bf16 v[32:47], v[68:71], v[132:135], v[32:47]
    v_lshlrev_b32 v88, 16, v100
    v_and_b32 v89, s77, v100
    v_lshlrev_b32 v90, 16, v101
    v_and_b32 v91, s77, v101
    v_lshlrev_b32 v92, 16, v102
    v_and_b32 v93, s77, v102
    v_lshlrev_b32 v94, 16, v103
    v_and_b32 v95, s77, v103
    v_fma_f32 v88, v88, v30, v31
    buffer_load_dwordx4 v7, s[44:47], s6 offen lds
    s_add_u32 s6, s6, s87
    s_add_u32 m0, m0, 4096
    ds_read_b64_tr_b16 v[68:69], v11 offset:10240
    ds_read_b64_tr_b16 v[70:71], v11 offset:10752
    ds_read_b128 v[168:171], v18 offset:10240
    ds_read_b128 v[172:175], v19 offset:11264
    ds_read_b128 v[176:179], v16 offset:12288
    s_waitcnt lgkmcnt(15)
    v_mfma_f32_32x32x16_bf16 v[32:47], v[72:75], v[136:139], v[32:47]
    v_fma_f32 v89, v89, v30, v31
    v_fma_f32 v90, v90, v30, v31
    v_fma_f32 v91, v91, v30, v31
    v_fma_f32 v92, v92, v30, v31
    v_fma_f32 v93, v93, v30, v31
    v_fma_f32 v94, v94, v30, v31
    v_fma_f32 v95, v95, v30, v31
    v_cvt_pk_bf16_f32 v100, v88, v89
    v_cvt_pk_bf16_f32 v101, v90, v91
    ds_read_b64_tr_b16 v[72:73], v11 offset:12288
    ds_read_b64_tr_b16 v[74:75], v11 offset:12800
    ds_read_b128 v[180:183], v17 offset:13312
    ds_read_b128 v[184:187], v18 offset:14336
    ds_read_b128 v[188:191], v19 offset:15360
    s_waitcnt lgkmcnt(15)
    v_mfma_f32_32x32x16_bf16 v[32:47], v[76:79], v[140:143], v[32:47]
    v_cvt_pk_bf16_f32 v102, v92, v93
    v_cvt_pk_bf16_f32 v103, v94, v95
    v_lshlrev_b32 v80, 16, v104
    v_and_b32 v81, s77, v104
    v_lshlrev_b32 v82, 16, v105
    v_and_b32 v83, s77, v105
    v_lshlrev_b32 v84, 16, v106
    v_and_b32 v85, s77, v106
    buffer_load_dwordx4 v7, s[44:47], s6 offen lds
    s_add_u32 s6, s6, s87
    s_add_u32 m0, m0, 4096
    ds_read_b64_tr_b16 v[76:77], v11 offset:14336
    ds_read_b64_tr_b16 v[78:79], v11 offset:14848
    s_waitcnt lgkmcnt(15)
    v_mfma_f32_32x32x16_bf16 v[32:47], v[64:67], v[144:147], v[32:47]
    v_lshlrev_b32 v86, 16, v107
    v_and_b32 v87, s77, v107
    v_fma_f32 v80, v80, v28, v29
    v_fma_f32 v81, v81, v28, v29
    v_fma_f32 v82, v82, v28, v29
    v_fma_f32 v83, v83, v28, v29
    v_fma_f32 v84, v84, v28, v29
    v_fma_f32 v85, v85, v28, v29
    v_fma_f32 v86, v86, v28, v29
    s_waitcnt lgkmcnt(2)
    s_waitcnt vmcnt(9)
    s_barrier
    ds_read_b64_tr_b16 v[64:65], v11 offset:16384
    ds_read_b64_tr_b16 v[66:67], v11 offset:16896
    v_mfma_f32_32x32x16_bf16 v[32:47], v[68:71], v[148:151], v[32:47]
    v_fma_f32 v87, v87, v28, v29
    v_cvt_pk_bf16_f32 v104, v80, v81
    v_cvt_pk_bf16_f32 v105, v82, v83
    v_cvt_pk_bf16_f32 v106, v84, v85
    v_cvt_pk_bf16_f32 v107, v86, v87
    v_lshlrev_b32 v88, 16, v108
    v_and_b32 v89, s77, v108
    v_lshlrev_b32 v90, 16, v109
    ds_write_b128 v9, v[96:99] offset:0
    ds_write_b128 v9, v[100:103] offset:128
    ds_write_b128 v9, v[104:107] offset:4096
    ds_read_b64_tr_b16 v[68:69], v11 offset:18432
    ds_read_b64_tr_b16 v[70:71], v11 offset:18944
    v_mfma_f32_32x32x16_bf16 v[32:47], v[72:75], v[152:155], v[32:47]
    v_and_b32 v91, s77, v109
    v_lshlrev_b32 v92, 16, v110
    v_and_b32 v93, s77, v110
    v_lshlrev_b32 v94, 16, v111
    v_and_b32 v95, s77, v111
    v_fma_f32 v88, v88, v30, v31
    v_fma_f32 v89, v89, v30, v31
    v_fma_f32 v90, v90, v30, v31
    v_fma_f32 v91, v91, v30, v31
    buffer_load_dwordx4 v7, s[44:47], s6 offen lds
    s_add_u32 s6, s6, s87
    s_add_u32 m0, m0, 4096
    ds_read_b64_tr_b16 v[72:73], v11 offset:20480
    ds_read_b64_tr_b16 v[74:75], v11 offset:20992
    s_waitcnt lgkmcnt(9)
    v_mfma_f32_32x32x16_bf16 v[32:47], v[76:79], v[156:159], v[32:47]
    v_fma_f32 v92, v92, v30, v31
    v_fma_f32 v93, v93, v30, v31
    v_fma_f32 v94, v94, v30, v31
    v_fma_f32 v95, v95, v30, v31
    v_cvt_pk_bf16_f32 v108, v88, v89
    v_cvt_pk_bf16_f32 v109, v90, v91
    v_cvt_pk_bf16_f32 v110, v92, v93
    v_cvt_pk_bf16_f32 v111, v94, v95
    ds_write_b128 v9, v[108:111] offset:4224
    ds_read_b64_tr_b16 v[76:77], v11 offset:22528
    ds_read_b64_tr_b16 v[78:79], v11 offset:23040
    s_waitcnt lgkmcnt(10)
    v_mfma_f32_32x32x16_bf16 v[32:47], v[64:67], v[160:163], v[32:47]
    v_lshlrev_b32 v80, 16, v112
    v_and_b32 v81, s77, v112
    v_lshlrev_b32 v82, 16, v113
    v_and_b32 v83, s77, v113
    v_lshlrev_b32 v84, 16, v114
    v_and_b32 v85, s77, v114
    v_lshlrev_b32 v86, 16, v115
    v_and_b32 v87, s77, v115
    v_fma_f32 v80, v80, v28, v29
    s_cmp_eq_u32 s75, 0
    s_nop 0
    s_cbranch_scc0 L_C6
    buffer_load_dwordx4 v7, s[44:47], s6 offen lds
    s_add_u32 s6, s6, s87
    s_add_u32 m0, m0, 4096
L_C6:
    ds_read_b64_tr_b16 v[64:65], v11 offset:24576
    ds_read_b64_tr_b16 v[66:67], v11 offset:25088
    s_waitcnt lgkmcnt(7)
    v_mfma_f32_32x32x16_bf16 v[32:47], v[68:71], v[164:167], v[32:47]
    v_fma_f32 v81, v81, v28, v29
    v_fma_f32 v82, v82, v28, v29
    v_fma_f32 v83, v83, v28, v29
    v_fma_f32 v84, v84, v28, v29
    v_fma_f32 v85, v85, v28, v29
    v_fma_f32 v86, v86, v28, v29
    v_fma_f32 v87, v87, v28, v29
    v_cvt_pk_bf16_f32 v112, v80, v81
    v_cvt_pk_bf16_f32 v113, v82, v83
    s_cmp_eq_u32 s75, 1
    s_nop 0
    s_cbranch_scc0 L_C7
    s_cmp_lt_u32 s76, 2
    s_cselect_b64 s[64:65], s[28:29], s[20:21]
    s_cselect_b32 s73, 25, 7
    s_mov_b32 s66, 401408
    s_cselect_b32 s66, 1605632, s66
    s_and_b32 s3, s68, 1
    s_lshl_b32 s85, s2, 1
    s_add_u32 s3, s3, s85
    s_mul_i32 s3, s3, s73
    s_lshl_b32 s3, s3, 7
    v_lshlrev_b32 v5, 7, v1
    s_bfm_b64 exec, s73, 0
    buffer_load_dword v124, v5, s[64:67], s3 offen
    s_mov_b64 exec, -1
L_C7:
    ds_read_b64_tr_b16 v[68:69], v11 offset:26624
    ds_read_b64_tr_b16 v[70:71], v11 offset:27136
    s_waitcnt lgkmcnt(7)
    v_mfma_f32_32x32x16_bf16 v[32:47], v[72:75], v[168:171], v[32:47]
    v_cvt_pk_bf16_f32 v114, v84, v85
    v_cvt_pk_bf16_f32 v115, v86, v87
    v_lshlrev_b32 v88, 16, v116
    v_and_b32 v89, s77, v116
    v_lshlrev_b32 v90, 16, v117
    v_and_b32 v91, s77, v117
    v_lshlrev_b32 v92, 16, v118
    v_and_b32 v93, s77, v118
    ds_write_b128 v9, v[112:115] offset:8192
    s_waitcnt lgkmcnt(5)
    v_mfma_f32_32x32x16_bf16 v[32:47], v[76:79], v[172:175], v[32:47]
    v_lshlrev_b32 v94, 16, v119
    v_and_b32 v95, s77, v119
    v_fma_f32 v88, v88, v30, v31
    v_fma_f32 v89, v89, v30, v31
    v_fma_f32 v90, v90, v30, v31
    v_fma_f32 v91, v91, v30, v31
    v_fma_f32 v92, v92, v30, v31
    v_fma_f32 v93, v93, v30, v31
    v_fma_f32 v94, v94, v30, v31
    s_waitcnt lgkmcnt(3)
    v_mfma_f32_32x32x16_bf16 v[32:47], v[64:67], v[176:179], v[32:47]
    v_fma_f32 v95, v95, v30, v31
    v_cvt_pk_bf16_f32 v116, v88, v89
    v_cvt_pk_bf16_f32 v117, v90, v91
    v_cvt_pk_bf16_f32 v118, v92, v93
    v_cvt_pk_bf16_f32 v119, v94, v95
    ds_write_b128 v9, v[116:119] offset:8320
    s_waitcnt lgkmcnt(2)
    v_mfma_f32_32x32x16_bf16 v[32:47], v[68:71], v[180:183], v[32:47]
    s_waitcnt lgkmcnt(0)
    s_waitcnt vmcnt(4)
    s_barrier
    ds_read_b64_tr_b16 v[72:73], v12 offset:0
    ds_read_b64_tr_b16 v[74:75], v12 offset:512
    ds_read_b64_tr_b16 v[76:77], v12 offset:2048
    ds_read_b64_tr_b16 v[78:79], v12 offset:2560
    ds_read_b64_tr_b16 v[64:65], v12 offset:4096
    ds_read_b64_tr_b16 v[66:67], v12 offset:4608
    ds_read_b128 v[192:195], v16 offset:0
    ds_read_b128 v[196:199], v17 offset:1024
    ds_read_b128 v[200:203], v18 offset:2048
    ds_read_b128 v[204:207], v19 offset:3072
    ds_read_b128 v[208:211], v16 offset:4096
    ds_read_b128 v[212:215], v17 offset:5120
    ds_read_b64_tr_b16 v[68:69], v12 offset:6144
    ds_read_b64_tr_b16 v[70:71], v12 offset:6656
    s_waitcnt lgkmcnt(12)
    v_mfma_f32_32x32x16_bf16 v[32:47], v[72:75], v[184:187], v[32:47]
    ds_read_b64_tr_b16 v[72:73], v12 offset:8192
    ds_read_b64_tr_b16 v[74:75], v12 offset:8704
    s_waitcnt lgkmcnt(12)
    v_mfma_f32_32x32x16_bf16 v[32:47], v[76:79], v[188:191], v[32:47]
    ds_read_b128 v[216:219], v18 offset:6144
    ds_read_b128 v[220:223], v19 offset:7168
    ds_read_b128 v[224:227], v16 offset:8192
    ds_read_b128 v[228:231], v17 offset:9216
    ds_read_b128 v[232:235], v18 offset:10240
    ds_read_b128 v[236:239], v19 offset:11264
    ds_read_b64_tr_b16 v[76:77], v12 offset:10240
    ds_read_b64_tr_b16 v[78:79], v12 offset:10752
    s_waitcnt lgkmcnt(15)
    s_waitcnt lgkmcnt(15)
    v_mfma_f32_32x32x16_bf16 v[32:47], v[64:67], v[192:195], v[32:47]
    ds_read_b64_tr_b16 v[64:65], v12 offset:12288
    ds_read_b64_tr_b16 v[66:67], v12 offset:12800
    s_waitcnt lgkmcnt(12)
    v_mfma_f32_32x32x16_bf16 v[32:47], v[68:71], v[196:199], v[32:47]
    ds_read_b64_tr_b16 v[68:69], v12 offset:14336
    ds_read_b64_tr_b16 v[70:71], v12 offset:14848
    s_waitcnt lgkmcnt(12)
    v_mfma_f32_32x32x16_bf16 v[32:47], v[72:75], v[200:203], v[32:47]
    s_waitcnt lgkmcnt(6)
    s_barrier
    s_mov_b64 s[64:65], s[44:45]
    s_mov_b32 s66, s46
    s_mov_b32 s87, 114688
    s_mov_b32 s3, 114688
    s_mov_b32 s86, s8
    s_cmp_eq_u32 s75, 0
    s_cselect_b32 s3, 86016, s3
    s_cselect_b32 s86, s7, s86
    v_mov_b32 v122, v7
    s_add_u32 m0, s93, s3
    ds_read_b64_tr_b16 v[72:73], v12 offset:16384
    ds_read_b64_tr_b16 v[74:75], v12 offset:16896
    s_waitcnt lgkmcnt(6)
    v_mfma_f32_32x32x16_bf16 v[32:47], v[76:79], v[204:207], v[32:47]
    ds_read_b64_tr_b16 v[76:77], v12 offset:18432
    ds_read_b64_tr_b16 v[78:79], v12 offset:18944
    s_waitcnt lgkmcnt(6)
    v_mfma_f32_32x32x16_bf16 v[32:47], v[64:67], v[208:211], v[32:47]
    buffer_load_dwordx4 v122, s[64:67], s86 offen lds
    s_add_u32 m0, m0, 4096
    s_add_u32 s86, s86, s87
    ds_read_b64_tr_b16 v[64:65], v12 offset:20480
    ds_read_b64_tr_b16 v[66:67], v12 offset:20992
    s_waitcnt lgkmcnt(6)
    v_mfma_f32_32x32x16_bf16 v[32:47], v[68:71], v[212:215], v[32:47]
    buffer_load_dwordx4 v122, s[64:67], s86 offen lds
    s_add_u32 m0, m0, 4096
    s_add_u32 s86, s86, s87
    ds_read_b64_tr_b16 v[68:69], v12 offset:22528
    ds_read_b64_tr_b16 v[70:71], v12 offset:23040
    s_waitcnt lgkmcnt(6)
    v_mfma_f32_32x32x16_bf16 v[32:47], v[72:75], v[216:219], v[32:47]
    buffer_load_dwordx4 v122, s[64:67], s86 offen lds
    s_add_u32 m0, m0, 4096
    s_add_u32 s86, s86, s87
    ds_read_b64_tr_b16 v[72:73], v12 offset:24576
    ds_read_b64_tr_b16 v[74:75], v12 offset:25088
    s_waitcnt lgkmcnt(6)
    v_mfma_f32_32x32x16_bf16 v[32:47], v[76:79], v[220:223], v[32:47]
    buffer_load_dwordx4 v122, s[64:67], s86 offen lds
    s_add_u32 m0, m0, 4096
    s_add_u32 s86, s86, s87
    ds_read_b64_tr_b16 v[76:77], v12 offset:26624
    ds_read_b64_tr_b16 v[78:79], v12 offset:27136
    s_waitcnt lgkmcnt(6)
    v_mfma_f32_32x32x16_bf16 v[32:47], v[64:67], v[224:227], v[32:47]
    buffer_load_dwordx4 v122, s[64:67], s86 offen lds
    s_add_u32 m0, m0, 4096
    s_add_u32 s86, s86, s87
    s_waitcnt lgkmcnt(4)
    v_mfma_f32_32x32x16_bf16 v[32:47], v[68:71], v[228:231], v[32:47]
    s_lshl_b32 s3, s94, 5
    s_add_u32 s3, s3, 0
    s_add_u32 s80, s3, s81
    s_lshl_b32 s3, s94, 1
    v_add_u32 v2, s3, v15
    ds_read_b128 v[48:51], v2 offset:2048
    ds_read_b128 v[52:55], v2 offset:2080
    ds_read_b128 v[56:59], v2 offset:2112
    ds_read_b128 v[60:63], v2 offset:2144
    v_add_u32 v11, 57344, v10
    v_add_u32 v12, 86016, v10
    buffer_load_dwordx4 v122, s[64:67], s86 offen lds
    s_add_u32 m0, m0, 4096
    s_add_u32 s86, s86, s87
    s_waitcnt lgkmcnt(2)
    v_mfma_f32_32x32x16_bf16 v[32:47], v[72:75], v[232:235], v[32:47]
    buffer_load_dwordx4 v122, s[64:67], s86 offen lds
    s_add_u32 m0, m0, 4096
    s_add_u32 s86, s86, s87
    s_waitcnt lgkmcnt(0)
    v_mfma_f32_32x32x16_bf16 v[104:119], v[76:79], v[236:239], v[32:47]
    s_mul_i32 s3, s75, 344064
    s_add_u32 s86, s9, s3
    s_mul_i32 s3, s75, 12288
    s_add_u32 m0, s93, s3
    s_waitcnt vmcnt(7)
    s_barrier
    ds_read_b64_tr_b16 v[64:65], v11 offset:0
    ds_read_b64_tr_b16 v[66:67], v11 offset:512
    ds_read_b64_tr_b16 v[68:69], v11 offset:2048
    ds_read_b64_tr_b16 v[70:71], v11 offset:2560
    ds_read_b64_tr_b16 v[72:73], v11 offset:4096
    ds_read_b64_tr_b16 v[74:75], v11 offset:4608
    v_fma_f32 v80, v104, v104, s79
    v_fma_f32 v81, v105, v105, s79
    v_fma_f32 v82, v106, v106, s79
    v_fma_f32 v83, v107, v107, s79
    v_fma_f32 v84, v108, v108, s79
    v_fma_f32 v85, v109, v109, s79
    v_fma_f32 v86, v110, v110, s79
    v_fma_f32 v87, v111, v111, s79
    v_fma_f32 v88, v112, v112, s79
    v_fma_f32 v89, v113, v113, s79
    v_fma_f32 v90, v114, v114, s79
    v_fma_f32 v91, v115, v115, s79
    v_fma_f32 v92, v116, v116, s79
    v_fma_f32 v93, v117, v117, s79
    v_fma_f32 v94, v118, v118, s79
    v_fma_f32 v95, v119, v119, s79
    v_mul_f32 v80, v80, v104
    v_mul_f32 v81, v81, v105
    v_mul_f32 v82, v82, v106
    v_mul_f32 v83, v83, v107
    v_mul_f32 v84, v84, v108
    v_mul_f32 v85, v85, v109
    v_mul_f32 v86, v86, v110
    v_mul_f32 v87, v87, v111
    v_mul_f32 v88, v88, v112
    v_mul_f32 v89, v89, v113
    v_mul_f32 v90, v90, v114
    v_mul_f32 v91, v91, v115
    v_mul_f32 v92, v92, v116
    v_mul_f32 v93, v93, v117
    v_mul_f32 v94, v94, v118
    v_mul_f32 v95, v95, v119
    v_exp_f32 v80, -v80
    s_setprio 1
    ds_read_b64_tr_b16 v[76:77], v11 offset:6144
    ds_read_b64_tr_b16 v[78:79], v11 offset:6656
    s_waitcnt lgkmcnt(6)
    v_mfma_f32_32x32x16_bf16 v[32:47], v[64:67], v[128:131], v[48:63]
    buffer_load_dwordx4 v122, s[64:67], s86 offen lds
    ds_read_b64_tr_b16 v[64:65], v11 offset:8192
    ds_read_b64_tr_b16 v[66:67], v11 offset:8704
    s_waitcnt lgkmcnt(6)
    v_mfma_f32_32x32x16_bf16 v[32:47], v[68:71], v[132:135], v[32:47]
    s_add_u32 m0, m0, 4096
    s_add_u32 s86, s86, s87
    ds_read_b64_tr_b16 v[68:69], v11 offset:10240
    ds_read_b64_tr_b16 v[70:71], v11 offset:10752
    s_waitcnt lgkmcnt(6)
    v_mfma_f32_32x32x16_bf16 v[32:47], v[72:75], v[136:139], v[32:47]
    buffer_load_dwordx4 v122, s[64:67], s86 offen lds
    ds_read_b64_tr_b16 v[72:73], v11 offset:12288
    ds_read_b64_tr_b16 v[74:75], v11 offset:12800
    s_waitcnt lgkmcnt(6)
    v_mfma_f32_32x32x16_bf16 v[32:47], v[76:79], v[140:143], v[32:47]
    s_add_u32 m0, m0, 4096
    s_add_u32 s86, s86, s87
    ds_read_b64_tr_b16 v[76:77], v11 offset:14336
    ds_read_b64_tr_b16 v[78:79], v11 offset:14848
    s_waitcnt lgkmcnt(6)
    v_mfma_f32_32x32x16_bf16 v[32:47], v[64:67], v[144:147], v[32:47]
    buffer_load_dwordx4 v122, s[64:67], s86 offen lds
    ds_read_b64_tr_b16 v[64:65], v11 offset:16384
    ds_read_b64_tr_b16 v[66:67], v11 offset:16896
    s_waitcnt lgkmcnt(6)
    v_mfma_f32_32x32x16_bf16 v[32:47], v[68:71], v[148:151], v[32:47]
    s_add_u32 m0, m0, 4096
    s_add_u32 s86, s86, s87
    ds_read_b64_tr_b16 v[68:69], v11 offset:18432
    ds_read_b64_tr_b16 v[70:71], v11 offset:18944
    s_waitcnt lgkmcnt(6)
    v_mfma_f32_32x32x16_bf16 v[32:47], v[72:75], v[152:155], v[32:47]
    buffer_load_dwordx4 v122, s[64:67], s86 offen lds
    s_setprio 0
    v_exp_f32 v81, -v81
    v_exp_f32 v82, -v82
    v_exp_f32 v83, -v83
    v_exp_f32 v84, -v84
    v_exp_f32 v85, -v85
    v_exp_f32 v86, -v86
    v_exp_f32 v87, -v87
    v_exp_f32 v88, -v88
    v_exp_f32 v89, -v89
    v_exp_f32 v90, -v90
    v_exp_f32 v91, -v91
    v_exp_f32 v92, -v92
    v_exp_f32 v93, -v93
    v_exp_f32 v94, -v94
    v_exp_f32 v95, -v95
    v_fma_f32 v80, v80, v14, v14
    v_fma_f32 v81, v81, v14, v14
    v_fma_f32 v82, v82, v14, v14
    v_fma_f32 v83, v83, v14, v14
    s_lshl_b32 s73, s83, 10
    s_lshl_b32 s22, s83, 11
    s_mul_i32 s98, s83, 14336
    s_lshr_b32 s3, s83, 1
    s_mul_i32 s89, s3, 25088
    s_and_b32 s3, s83, 1
    s_mul_i32 s3, s3, 14336
    s_add_u32 s89, s89, s3
    s_sub_u32 s82, s95, s73
    s_lshl_b32 s3, s76, 10
    s_add_u32 s82, s82, s3
    s_lshl_b32 s3, s75, 15
    s_add_u32 s82, s82, s3
    s_mul_i32 s100, s76, 14336
    s_add_u32 s100, s100, 1376256
    s_lshr_b32 s3, s76, 1
    s_mul_i32 s101, s3, 25088
    s_and_b32 s3, s76, 1
    s_mul_i32 s3, s3, 14336
    s_add_u32 s101, s101, s3
    s_add_u32 s101, s101, 200704
    s_cmp_eq_u32 s75, 0
    s_cselect_b32 s100, s100, s101
    s_mov_b32 s101, 50176
    s_cselect_b32 s101, 57344, s101
    v_lshlrev_b32 v19, 9, v1
    v_and_b32 v2, 3, v1
    v_lshlrev_b32 v2, 3, v2
    v_and_b32 v3, 16, v1
    v_lshl_add_u32 v2, v3, 1, v2
    v_and_b32 v3, 8, v1
    v_lshl_add_u32 v2, v3, 3, v2
    v_and_b32 v3, 12, v1
    v_lshl_add_u32 v2, v3, 5, v2
    v_lshrrev_b32 v4, 5, v1
    v_lshl_add_u32 v18, v4, 9, v2
    v_add_u32 v18, s22, v18
    v_add_u32 v9, 147456, v13
    s_setprio 1
    ds_read_b64_tr_b16 v[72:73], v11 offset:20480
    ds_read_b64_tr_b16 v[74:75], v11 offset:20992
    s_waitcnt lgkmcnt(6)
    v_mfma_f32_32x32x16_bf16 v[32:47], v[76:79], v[156:159], v[32:47]
    ds_read_b64_tr_b16 v[76:77], v11 offset:22528
    ds_read_b64_tr_b16 v[78:79], v11 offset:23040
    s_waitcnt lgkmcnt(6)
    v_mfma_f32_32x32x16_bf16 v[32:47], v[64:67], v[160:163], v[32:47]
    s_cmp_lg_u32 s68, 7
    s_nop 9
    s_cbranch_scc1 L_W78
    v_lshlrev_b32 v3, 2, v1
    s_mov_b64 exec, 0xffffffff
    buffer_load_dword v120, v3, s[52:55], 0 offen sc1
    s_mov_b64 exec, -1
L_W78:
    ds_read_b64_tr_b16 v[64:65], v11 offset:24576
    ds_read_b64_tr_b16 v[66:67], v11 offset:25088
    s_waitcnt lgkmcnt(6)
    v_mfma_f32_32x32x16_bf16 v[32:47], v[68:71], v[164:167], v[32:47]
    ds_read_b64_tr_b16 v[68:69], v11 offset:26624
    ds_read_b64_tr_b16 v[70:71], v11 offset:27136
    s_waitcnt lgkmcnt(6)
    v_mfma_f32_32x32x16_bf16 v[32:47], v[72:75], v[168:171], v[32:47]
    s_waitcnt vmcnt(4)
    s_barrier
    ds_read_b64_tr_b16 v[72:73], v12 offset:0
    ds_read_b64_tr_b16 v[74:75], v12 offset:512
    s_waitcnt lgkmcnt(6)
    v_mfma_f32_32x32x16_bf16 v[32:47], v[76:79], v[172:175], v[32:47]
    ds_read_b64_tr_b16 v[76:77], v12 offset:2048
    ds_read_b64_tr_b16 v[78:79], v12 offset:2560
    s_waitcnt lgkmcnt(6)
    v_mfma_f32_32x32x16_bf16 v[32:47], v[64:67], v[176:179], v[32:47]
    s_add_u32 m0, s22, 28672
    s_add_u32 s3, s98, 0
    buffer_load_dwordx4 v6, s[56:59], s3 offen lds
    ds_read_b64_tr_b16 v[64:65], v12 offset:4096
    ds_read_b64_tr_b16 v[66:67], v12 offset:4608
    s_waitcnt lgkmcnt(6)
    v_mfma_f32_32x32x16_bf16 v[32:47], v[68:71], v[180:183], v[32:47]
    s_setprio 0
    v_fma_f32 v84, v84, v14, v14
    v_fma_f32 v85, v85, v14, v14
    v_fma_f32 v86, v86, v14, v14
    v_fma_f32 v87, v87, v14, v14
    v_fma_f32 v88, v88, v14, v14
    v_fma_f32 v89, v89, v14, v14
    v_fma_f32 v90, v90, v14, v14
    v_fma_f32 v91, v91, v14, v14
    v_fma_f32 v92, v92, v14, v14
    v_fma_f32 v93, v93, v14, v14
    v_fma_f32 v94, v94, v14, v14
    v_fma_f32 v95, v95, v14, v14
    v_rcp_f32 v80, v80
    v_rcp_f32 v81, v81
    v_rcp_f32 v82, v82
    v_rcp_f32 v83, v83
    v_rcp_f32 v84, v84
    v_rcp_f32 v85, v85
    v_rcp_f32 v86, v86
    v_rcp_f32 v87, v87
    v_rcp_f32 v88, v88
    v_rcp_f32 v89, v89
    v_rcp_f32 v90, v90
    s_setprio 1
    ds_read_b64_tr_b16 v[68:69], v12 offset:6144
    ds_read_b64_tr_b16 v[70:71], v12 offset:6656
    s_waitcnt lgkmcnt(6)
    v_mfma_f32_32x32x16_bf16 v[32:47], v[72:75], v[184:187], v[32:47]
    ds_read_b64_tr_b16 v[72:73], v12 offset:8192
    ds_read_b64_tr_b16 v[74:75], v12 offset:8704
    s_waitcnt lgkmcnt(6)
    v_mfma_f32_32x32x16_bf16 v[32:47], v[76:79], v[188:191], v[32:47]
    s_add_u32 m0, s22, 29696
    s_add_u32 s3, s98, 7168
    buffer_load_dwordx4 v6, s[56:59], s3 offen lds
    ds_read_b64_tr_b16 v[76:77], v12 offset:10240
    ds_read_b64_tr_b16 v[78:79], v12 offset:10752
    s_waitcnt lgkmcnt(6)
    v_mfma_f32_32x32x16_bf16 v[32:47], v[64:67], v[192:195], v[32:47]
    ds_read_b64_tr_b16 v[64:65], v12 offset:12288
    ds_read_b64_tr_b16 v[66:67], v12 offset:12800
    s_waitcnt lgkmcnt(6)
    v_mfma_f32_32x32x16_bf16 v[32:47], v[68:71], v[196:199], v[32:47]
    ds_read_b64_tr_b16 v[68:69], v12 offset:14336
    ds_read_b64_tr_b16 v[70:71], v12 offset:14848
    s_waitcnt lgkmcnt(6)
    v_mfma_f32_32x32x16_bf16 v[32:47], v[72:75], v[200:203], v[32:47]
    ds_read_b64_tr_b16 v[72:73], v12 offset:16384
    ds_read_b64_tr_b16 v[74:75], v12 offset:16896
    s_waitcnt lgkmcnt(6)
    v_mfma_f32_32x32x16_bf16 v[32:47], v[76:79], v[204:207], v[32:47]
    ds_read_b64_tr_b16 v[76:77], v12 offset:18432
    ds_read_b64_tr_b16 v[78:79], v12 offset:18944
    s_waitcnt lgkmcnt(6)
    v_mfma_f32_32x32x16_bf16 v[32:47], v[64:67], v[208:211], v[32:47]
    s_setprio 0
    v_rcp_f32 v91, v91
    v_rcp_f32 v92, v92
    v_rcp_f32 v93, v93
    v_rcp_f32 v94, v94
    v_rcp_f32 v95, v95
    v_mul_f32 v80, v80, v104
    v_mul_f32 v81, v81, v105
    v_mul_f32 v82, v82, v106
    v_mul_f32 v83, v83, v107
    v_mul_f32 v84, v84, v108
    v_mul_f32 v85, v85, v109
    v_mul_f32 v86, v86, v110
    v_mul_f32 v87, v87, v111
    v_mul_f32 v88, v88, v112
    v_mul_f32 v89, v89, v113
    v_mul_f32 v90, v90, v114
    v_mul_f32 v91, v91, v115
    v_mul_f32 v92, v92, v116
    v_mul_f32 v93, v93, v117
    v_mul_f32 v94, v94, v118
    v_mul_f32 v95, v95, v119
    v_cvt_pk_bf16_f32 v96, v80, v81
    v_cvt_pk_bf16_f32 v97, v82, v83
    v_cvt_pk_bf16_f32 v98, v84, v85
    v_cvt_pk_bf16_f32 v99, v86, v87
    v_cvt_pk_bf16_f32 v100, v88, v89
    v_cvt_pk_bf16_f32 v101, v90, v91
    v_cvt_pk_bf16_f32 v102, v92, v93
    v_cvt_pk_bf16_f32 v103, v94, v95
    buffer_store_dwordx4 v[96:99], v13, s[48:51], s80 offen sc1
    buffer_store_dwordx4 v[100:103], v13, s[48:51], s80 offen offset:1024 sc1
    s_setprio 1
    ds_read_b64_tr_b16 v[64:65], v12 offset:20480
    ds_read_b64_tr_b16 v[66:67], v12 offset:20992
    s_waitcnt lgkmcnt(6)
    v_mfma_f32_32x32x16_bf16 v[32:47], v[68:71], v[212:215], v[32:47]
    ds_read_b64_tr_b16 v[68:69], v12 offset:22528
    ds_read_b64_tr_b16 v[70:71], v12 offset:23040
    s_waitcnt lgkmcnt(6)
    v_mfma_f32_32x32x16_bf16 v[32:47], v[72:75], v[216:219], v[32:47]
    ds_read_b64_tr_b16 v[72:73], v12 offset:24576
    ds_read_b64_tr_b16 v[74:75], v12 offset:25088
    s_waitcnt lgkmcnt(6)
    v_mfma_f32_32x32x16_bf16 v[32:47], v[76:79], v[220:223], v[32:47]
    ds_read_b64_tr_b16 v[76:77], v12 offset:26624
    ds_read_b64_tr_b16 v[78:79], v12 offset:27136
    s_waitcnt lgkmcnt(6)
    v_mfma_f32_32x32x16_bf16 v[32:47], v[64:67], v[224:227], v[32:47]
    s_waitcnt lgkmcnt(4)
    v_mfma_f32_32x32x16_bf16 v[32:47], v[68:71], v[228:231], v[32:47]
    s_lshl_b32 s3, s94, 1
    v_add_u32 v2, s3, v15
    ds_read_b128 v[48:51], v2 offset:4096
    ds_read_b128 v[52:55], v2 offset:4128
    ds_read_b128 v[56:59], v2 offset:4160
    ds_read_b128 v[60:63], v2 offset:4192
    v_add_u32 v11, 114688, v10
    v_add_u32 v12, 0, v10
    s_lshl_b32 s3, s94, 5
    s_add_u32 s3, s3, 32768
    s_add_u32 s80, s3, s81
    s_cmp_lg_u32 s68, 7
    s_cbranch_scc1 L_W79
    s_waitcnt vmcnt(2)
    s_mov_b32 s85, 0
L_FC10:
    v_cmp_ne_u32 vcc, 0, v120
    s_nop 1
    s_and_b32 s3, vcc_lo, 0xffff00ff
    s_cmp_eq_u32 s3, 0xffff00ff
    s_cbranch_scc1 L_FD11
    s_add_u32 s85, s85, 1
    s_cmp_gt_u32 s85, 200000
    s_cbranch_scc1 L_FD11
    v_lshlrev_b32 v3, 2, v1
    s_mov_b64 exec, 0xffffffff
    buffer_load_dword v120, v3, s[52:55], 0 offen sc1
    s_mov_b64 exec, -1
    s_waitcnt vmcnt(0)
    s_branch L_FC10
L_FD11:
L_W79:
    s_waitcnt lgkmcnt(2)
    v_mfma_f32_32x32x16_bf16 v[32:47], v[72:75], v[232:235], v[32:47]
    s_waitcnt lgkmcnt(0)
    v_mfma_f32_32x32x16_bf16 v[104:119], v[76:79], v[236:239], v[32:47]
    s_setprio 0
    s_cmp_eq_u32 s90, 0
    s_nop 8
    s_cbranch_scc1 L_LONG
    s_waitcnt vmcnt(4)
    s_barrier
    ds_read_b64_tr_b16 v[64:65], v11 offset:0
    ds_read_b64_tr_b16 v[66:67], v11 offset:512
    ds_read_b64_tr_b16 v[68:69], v11 offset:2048
    ds_read_b64_tr_b16 v[70:71], v11 offset:2560
    ds_read_b64_tr_b16 v[72:73], v11 offset:4096
    ds_read_b64_tr_b16 v[74:75], v11 offset:4608
    v_fma_f32 v80, v104, v104, s79
    v_fma_f32 v81, v105, v105, s79
    v_fma_f32 v82, v106, v106, s79
    v_fma_f32 v83, v107, v107, s79
    v_fma_f32 v84, v108, v108, s79
    v_fma_f32 v85, v109, v109, s79
    v_fma_f32 v86, v110, v110, s79
    v_fma_f32 v87, v111, v111, s79
    v_fma_f32 v88, v112, v112, s79
    v_fma_f32 v89, v113, v113, s79
    v_fma_f32 v90, v114, v114, s79
    v_fma_f32 v91, v115, v115, s79
    v_fma_f32 v92, v116, v116, s79
    v_fma_f32 v93, v117, v117, s79
    v_fma_f32 v94, v118, v118, s79
    v_fma_f32 v95, v119, v119, s79
    v_mul_f32 v80, v80, v104
    v_mul_f32 v81, v81, v105
    v_mul_f32 v82, v82, v106
    v_mul_f32 v83, v83, v107
    v_mul_f32 v84, v84, v108
    v_mul_f32 v85, v85, v109
    v_mul_f32 v86, v86, v110
    v_mul_f32 v87, v87, v111
    v_mul_f32 v88, v88, v112
    v_mul_f32 v89, v89, v113
    v_mul_f32 v90, v90, v114
    v_mul_f32 v91, v91, v115
    v_mul_f32 v92, v92, v116
    v_mul_f32 v93, v93, v117
    v_mul_f32 v94, v94, v118
    v_mul_f32 v95, v95, v119
    v_exp_f32 v80, -v80
    s_setprio 1
    ds_read_b64_tr_b16 v[76:77], v11 offset:6144
    ds_read_b64_tr_b16 v[78:79], v11 offset:6656
    s_waitcnt lgkmcnt(6)
    v_mfma_f32_32x32x16_bf16 v[32:47], v[64:67], v[128:131], v[48:63]
    s_add_u32 m0, s22, 45056
    s_add_u32 s3, s98, 114688
    buffer_load_dwordx4 v6, s[56:59], s3 offen lds
    ds_read_b64_tr_b16 v[64:65], v11 offset:8192
    ds_read_b64_tr_b16 v[66:67], v11 offset:8704
    s_waitcnt lgkmcnt(6)
    v_mfma_f32_32x32x16_bf16 v[32:47], v[68:71], v[132:135], v[32:47]
    ds_read_b64_tr_b16 v[68:69], v11 offset:10240
    ds_read_b64_tr_b16 v[70:71], v11 offset:10752
    s_waitcnt lgkmcnt(6)
    v_mfma_f32_32x32x16_bf16 v[32:47], v[72:75], v[136:139], v[32:47]
    ds_read_b64_tr_b16 v[72:73], v11 offset:12288
    ds_read_b64_tr_b16 v[74:75], v11 offset:12800
    s_waitcnt lgkmcnt(6)
    v_mfma_f32_32x32x16_bf16 v[32:47], v[76:79], v[140:143], v[32:47]
    s_add_u32 m0, s22, 46080
    s_add_u32 s3, s98, 121856
    buffer_load_dwordx4 v6, s[56:59], s3 offen lds
    ds_read_b64_tr_b16 v[76:77], v11 offset:14336
    ds_read_b64_tr_b16 v[78:79], v11 offset:14848
    s_waitcnt lgkmcnt(6)
    v_mfma_f32_32x32x16_bf16 v[32:47], v[64:67], v[144:147], v[32:47]
    ds_read_b64_tr_b16 v[64:65], v11 offset:16384
    ds_read_b64_tr_b16 v[66:67], v11 offset:16896
    s_waitcnt lgkmcnt(6)
    v_mfma_f32_32x32x16_bf16 v[32:47], v[68:71], v[148:151], v[32:47]
    ds_read_b64_tr_b16 v[68:69], v11 offset:18432
    ds_read_b64_tr_b16 v[70:71], v11 offset:18944
    s_waitcnt lgkmcnt(6)
    v_mfma_f32_32x32x16_bf16 v[32:47], v[72:75], v[152:155], v[32:47]
    s_add_u32 m0, s22, 61440
    s_add_u32 s3, s98, 229376
    buffer_load_dwordx4 v6, s[56:59], s3 offen lds
    s_setprio 0
    v_exp_f32 v81, -v81
    v_exp_f32 v82, -v82
    v_exp_f32 v83, -v83
    v_exp_f32 v84, -v84
    v_exp_f32 v85, -v85
    v_exp_f32 v86, -v86
    v_exp_f32 v87, -v87
    v_exp_f32 v88, -v88
    v_exp_f32 v89, -v89
    v_exp_f32 v90, -v90
    v_exp_f32 v91, -v91
    v_exp_f32 v92, -v92
    v_exp_f32 v93, -v93
    v_exp_f32 v94, -v94
    v_exp_f32 v95, -v95
    v_fma_f32 v80, v80, v14, v14
    v_fma_f32 v81, v81, v14, v14
    v_fma_f32 v82, v82, v14, v14
    v_fma_f32 v83, v83, v14, v14
    s_waitcnt vmcnt(3)
    v_mov_b32 v3, 163776
    v_mov_b32 v4, 1
    s_mov_b64 exec, 1
    ds_add_rtn_u32 v125, v3, v4
    s_mov_b64 exec, -1
    s_setprio 1
    ds_read_b64_tr_b16 v[72:73], v11 offset:20480
    ds_read_b64_tr_b16 v[74:75], v11 offset:20992
    s_waitcnt lgkmcnt(6)
    v_mfma_f32_32x32x16_bf16 v[32:47], v[76:79], v[156:159], v[32:47]
    ds_read_b64_tr_b16 v[76:77], v11 offset:22528
    ds_read_b64_tr_b16 v[78:79], v11 offset:23040
    s_waitcnt lgkmcnt(6)
    v_mfma_f32_32x32x16_bf16 v[32:47], v[64:67], v[160:163], v[32:47]
    ds_read_b64_tr_b16 v[64:65], v11 offset:24576
    ds_read_b64_tr_b16 v[66:67], v11 offset:25088
    s_waitcnt lgkmcnt(6)
    v_mfma_f32_32x32x16_bf16 v[32:47], v[68:71], v[164:167], v[32:47]
    s_add_u32 m0, s22, 62464
    s_add_u32 s3, s98, 236544
    buffer_load_dwordx4 v6, s[56:59], s3 offen lds
    ds_read_b64_tr_b16 v[68:69], v11 offset:26624
    ds_read_b64_tr_b16 v[70:71], v11 offset:27136
    s_waitcnt lgkmcnt(6)
    v_mfma_f32_32x32x16_bf16 v[32:47], v[72:75], v[168:171], v[32:47]
    v_readfirstlane_b32 s3, v125
    s_nop 1
    s_cmp_lg_u32 s3, 7
    s_nop 6
    s_cbranch_scc1 L_SB12
    v_mov_b32 v4, 1
    s_mov_b64 exec, 1
    buffer_store_dword v4, v23, s[48:51], s11 offen offset:0 sc1
    s_mov_b64 exec, -1
L_SB12:
    ds_read_b64_tr_b16 v[72:73], v12 offset:0
    ds_read_b64_tr_b16 v[74:75], v12 offset:512
    s_waitcnt lgkmcnt(6)
    v_mfma_f32_32x32x16_bf16 v[32:47], v[76:79], v[172:175], v[32:47]
    ds_read_b64_tr_b16 v[76:77], v12 offset:2048
    ds_read_b64_tr_b16 v[78:79], v12 offset:2560
    s_waitcnt lgkmcnt(6)
    v_mfma_f32_32x32x16_bf16 v[32:47], v[64:67], v[176:179], v[32:47]
    s_add_u32 m0, s22, 77824
    s_add_u32 s3, s98, 344064
    buffer_load_dwordx4 v6, s[56:59], s3 offen lds
    ds_read_b64_tr_b16 v[64:65], v12 offset:4096
    ds_read_b64_tr_b16 v[66:67], v12 offset:4608
    s_waitcnt lgkmcnt(6)
    v_mfma_f32_32x32x16_bf16 v[32:47], v[68:71], v[180:183], v[32:47]
    s_setprio 0
    v_fma_f32 v84, v84, v14, v14
    v_fma_f32 v85, v85, v14, v14
    v_fma_f32 v86, v86, v14, v14
    v_fma_f32 v87, v87, v14, v14
    v_fma_f32 v88, v88, v14, v14
    v_fma_f32 v89, v89, v14, v14
    v_fma_f32 v90, v90, v14, v14
    v_fma_f32 v91, v91, v14, v14
    v_fma_f32 v92, v92, v14, v14
    v_fma_f32 v93, v93, v14, v14
    v_fma_f32 v94, v94, v14, v14
    v_fma_f32 v95, v95, v14, v14
    v_rcp_f32 v80, v80
    v_rcp_f32 v81, v81
    v_rcp_f32 v82, v82
    v_rcp_f32 v83, v83
    v_rcp_f32 v84, v84
    v_rcp_f32 v85, v85
    v_rcp_f32 v86, v86
    v_rcp_f32 v87, v87
    v_rcp_f32 v88, v88
    v_rcp_f32 v89, v89
    v_rcp_f32 v90, v90
    s_setprio 1
    ds_read_b64_tr_b16 v[68:69], v12 offset:6144
    ds_read_b64_tr_b16 v[70:71], v12 offset:6656
    s_waitcnt lgkmcnt(6)
    v_mfma_f32_32x32x16_bf16 v[32:47], v[72:75], v[184:187], v[32:47]
    ds_read_b64_tr_b16 v[72:73], v12 offset:8192
    ds_read_b64_tr_b16 v[74:75], v12 offset:8704
    s_waitcnt lgkmcnt(6)
    v_mfma_f32_32x32x16_bf16 v[32:47], v[76:79], v[188:191], v[32:47]
    s_add_u32 m0, s22, 78848
    s_add_u32 s3, s98, 351232
    buffer_load_dwordx4 v6, s[56:59], s3 offen lds
    ds_read_b64_tr_b16 v[76:77], v12 offset:10240
    ds_read_b64_tr_b16 v[78:79], v12 offset:10752
    s_waitcnt lgkmcnt(6)
    v_mfma_f32_32x32x16_bf16 v[32:47], v[64:67], v[192:195], v[32:47]
    ds_read_b64_tr_b16 v[64:65], v12 offset:12288
    ds_read_b64_tr_b16 v[66:67], v12 offset:12800
    s_waitcnt lgkmcnt(6)
    v_mfma_f32_32x32x16_bf16 v[32:47], v[68:71], v[196:199], v[32:47]
    ds_read_b64_tr_b16 v[68:69], v12 offset:14336
    ds_read_b64_tr_b16 v[70:71], v12 offset:14848
    s_waitcnt lgkmcnt(6)
    v_mfma_f32_32x32x16_bf16 v[32:47], v[72:75], v[200:203], v[32:47]
    s_add_u32 m0, s22, 94208
    s_add_u32 s3, s98, 458752
    buffer_load_dwordx4 v6, s[56:59], s3 offen lds
    ds_read_b64_tr_b16 v[72:73], v12 offset:16384
    ds_read_b64_tr_b16 v[74:75], v12 offset:16896
    s_waitcnt lgkmcnt(6)
    v_mfma_f32_32x32x16_bf16 v[32:47], v[76:79], v[204:207], v[32:47]
    ds_read_b64_tr_b16 v[76:77], v12 offset:18432
    ds_read_b64_tr_b16 v[78:79], v12 offset:18944
    s_waitcnt lgkmcnt(6)
    v_mfma_f32_32x32x16_bf16 v[32:47], v[64:67], v[208:211], v[32:47]
    s_setprio 0
    v_rcp_f32 v91, v91
    v_rcp_f32 v92, v92
    v_rcp_f32 v93, v93
    v_rcp_f32 v94, v94
    v_rcp_f32 v95, v95
    v_mul_f32 v80, v80, v104
    v_mul_f32 v81, v81, v105
    v_mul_f32 v82, v82, v106
    v_mul_f32 v83, v83, v107
    v_mul_f32 v84, v84, v108
    v_mul_f32 v85, v85, v109
    v_mul_f32 v86, v86, v110
    v_mul_f32 v87, v87, v111
    v_mul_f32 v88, v88, v112
    v_mul_f32 v89, v89, v113
    v_mul_f32 v90, v90, v114
    v_mul_f32 v91, v91, v115
    v_mul_f32 v92, v92, v116
    v_mul_f32 v93, v93, v117
    v_mul_f32 v94, v94, v118
    v_mul_f32 v95, v95, v119
    v_cvt_pk_bf16_f32 v96, v80, v81
    v_cvt_pk_bf16_f32 v97, v82, v83
    v_cvt_pk_bf16_f32 v98, v84, v85
    v_cvt_pk_bf16_f32 v99, v86, v87
    v_cvt_pk_bf16_f32 v100, v88, v89
    v_cvt_pk_bf16_f32 v101, v90, v91
    v_cvt_pk_bf16_f32 v102, v92, v93
    v_cvt_pk_bf16_f32 v103, v94, v95
    buffer_store_dwordx4 v[96:99], v13, s[48:51], s80 offen sc1
    buffer_store_dwordx4 v[100:103], v13, s[48:51], s80 offen offset:1024 sc1
    s_setprio 1
    ds_read_b64_tr_b16 v[64:65], v12 offset:20480
    ds_read_b64_tr_b16 v[66:67], v12 offset:20992
    s_waitcnt lgkmcnt(6)
    v_mfma_f32_32x32x16_bf16 v[32:47], v[68:71], v[212:215], v[32:47]
    s_add_u32 m0, s22, 95232
    s_add_u32 s3, s98, 465920
    buffer_load_dwordx4 v6, s[56:59], s3 offen lds
    ds_read_b64_tr_b16 v[68:69], v12 offset:22528
    ds_read_b64_tr_b16 v[70:71], v12 offset:23040
    s_waitcnt lgkmcnt(6)
    v_mfma_f32_32x32x16_bf16 v[32:47], v[72:75], v[216:219], v[32:47]
    ds_read_b64_tr_b16 v[72:73], v12 offset:24576
    ds_read_b64_tr_b16 v[74:75], v12 offset:25088
    s_waitcnt lgkmcnt(6)
    v_mfma_f32_32x32x16_bf16 v[32:47], v[76:79], v[220:223], v[32:47]
    ds_read_b64_tr_b16 v[76:77], v12 offset:26624
    ds_read_b64_tr_b16 v[78:79], v12 offset:27136
    s_waitcnt lgkmcnt(6)
    v_mfma_f32_32x32x16_bf16 v[32:47], v[64:67], v[224:227], v[32:47]
    s_waitcnt lgkmcnt(4)
    v_mfma_f32_32x32x16_bf16 v[32:47], v[68:71], v[228:231], v[32:47]
    s_lshl_b32 s3, s94, 5
    s_add_u32 s3, s3, 65536
    s_add_u32 s80, s3, s81
    s_waitcnt lgkmcnt(2)
    v_mfma_f32_32x32x16_bf16 v[32:47], v[72:75], v[232:235], v[32:47]
    s_waitcnt lgkmcnt(0)
    v_mfma_f32_32x32x16_bf16 v[104:119], v[76:79], v[236:239], v[32:47]
    s_setprio 0
    s_barrier
    s_setprio 3
    s_cmp_lg_u32 s68, 0
    s_nop 6
    s_cbranch_scc1 L_PI13
    s_mov_b64 exec, 65280
    buffer_load_dword v248, v19, s[48:51], s13 offen offset:0 sc1
    s_mov_b64 exec, -1
L_PI13:
    s_add_u32 m0, s22, 114688
    s_add_u32 s3, s98, 573440
    buffer_load_dwordx4 v6, s[56:59], s3 offen lds
    s_add_u32 m0, s22, 115712
    s_add_u32 s3, s98, 580608
    buffer_load_dwordx4 v6, s[56:59], s3 offen lds
    s_add_u32 m0, s22, 131072
    s_add_u32 s3, s98, 688128
    buffer_load_dwordx4 v6, s[56:59], s3 offen lds
    s_add_u32 m0, s22, 132096
    s_add_u32 s3, s98, 695296
    buffer_load_dwordx4 v6, s[56:59], s3 offen lds
    v_fma_f32 v80, v104, v104, s79
    v_fma_f32 v81, v105, v105, s79
    v_fma_f32 v82, v106, v106, s79
    v_fma_f32 v83, v107, v107, s79
    v_fma_f32 v84, v108, v108, s79
    v_fma_f32 v85, v109, v109, s79
    v_fma_f32 v86, v110, v110, s79
    v_fma_f32 v87, v111, v111, s79
    v_fma_f32 v88, v112, v112, s79
    v_fma_f32 v89, v113, v113, s79
    v_fma_f32 v90, v114, v114, s79
    v_fma_f32 v91, v115, v115, s79
    v_fma_f32 v92, v116, v116, s79
    v_fma_f32 v93, v117, v117, s79
    v_fma_f32 v94, v118, v118, s79
    v_fma_f32 v95, v119, v119, s79
    v_mul_f32 v80, v80, v104
    v_mul_f32 v81, v81, v105
    v_mul_f32 v82, v82, v106
    v_mul_f32 v83, v83, v107
    v_mul_f32 v84, v84, v108
    v_mul_f32 v85, v85, v109
    v_mul_f32 v86, v86, v110
    v_mul_f32 v87, v87, v111
    v_mul_f32 v88, v88, v112
    v_mul_f32 v89, v89, v113
    v_mul_f32 v90, v90, v114
    v_mul_f32 v91, v91, v115
    v_mul_f32 v92, v92, v116
    v_mul_f32 v93, v93, v117
    v_mul_f32 v94, v94, v118
    v_mul_f32 v95, v95, v119
    v_exp_f32 v80, -v80
    v_exp_f32 v81, -v81
    v_exp_f32 v82, -v82
    v_exp_f32 v83, -v83
    v_exp_f32 v84, -v84
    v_exp_f32 v85, -v85
    v_exp_f32 v86, -v86
    v_exp_f32 v87, -v87
    v_exp_f32 v88, -v88
    v_exp_f32 v89, -v89
    v_exp_f32 v90, -v90
    v_exp_f32 v91, -v91
    v_exp_f32 v92, -v92
    v_exp_f32 v93, -v93
    v_exp_f32 v94, -v94
    v_exp_f32 v95, -v95
    v_fma_f32 v80, v80, v14, v14
    v_fma_f32 v81, v81, v14, v14
    v_fma_f32 v82, v82, v14, v14
    v_fma_f32 v83, v83, v14, v14
    v_fma_f32 v84, v84, v14, v14
    v_fma_f32 v85, v85, v14, v14
    v_fma_f32 v86, v86, v14, v14
    v_fma_f32 v87, v87, v14, v14
    v_fma_f32 v88, v88, v14, v14
    v_fma_f32 v89, v89, v14, v14
    v_fma_f32 v90, v90, v14, v14
    v_fma_f32 v91, v91, v14, v14
    v_fma_f32 v92, v92, v14, v14
    v_fma_f32 v93, v93, v14, v14
    v_fma_f32 v94, v94, v14, v14
    v_fma_f32 v95, v95, v14, v14
    v_rcp_f32 v80, v80
    v_rcp_f32 v81, v81
    v_rcp_f32 v82, v82
    v_rcp_f32 v83, v83
    v_rcp_f32 v84, v84
    v_rcp_f32 v85, v85
    v_rcp_f32 v86, v86
    v_rcp_f32 v87, v87
    v_rcp_f32 v88, v88
    v_rcp_f32 v89, v89
    v_rcp_f32 v90, v90
    v_rcp_f32 v91, v91
    v_rcp_f32 v92, v92
    v_rcp_f32 v93, v93
    v_rcp_f32 v94, v94
    v_rcp_f32 v95, v95
    v_mul_f32 v80, v80, v104
    v_mul_f32 v81, v81, v105
    v_mul_f32 v82, v82, v106
    v_mul_f32 v83, v83, v107
    v_mul_f32 v84, v84, v108
    v_mul_f32 v85, v85, v109
    v_mul_f32 v86, v86, v110
    v_mul_f32 v87, v87, v111
    v_mul_f32 v88, v88, v112
    v_mul_f32 v89, v89, v113
    v_mul_f32 v90, v90, v114
    v_mul_f32 v91, v91, v115
    v_mul_f32 v92, v92, v116
    v_mul_f32 v93, v93, v117
    v_mul_f32 v94, v94, v118
    v_mul_f32 v95, v95, v119
    v_cvt_pk_bf16_f32 v96, v80, v81
    v_cvt_pk_bf16_f32 v97, v82, v83
    v_cvt_pk_bf16_f32 v98, v84, v85
    v_cvt_pk_bf16_f32 v99, v86, v87
    v_cvt_pk_bf16_f32 v100, v88, v89
    v_cvt_pk_bf16_f32 v101, v90, v91
    v_cvt_pk_bf16_f32 v102, v92, v93
    v_cvt_pk_bf16_f32 v103, v94, v95
    buffer_store_dwordx4 v[96:99], v13, s[48:51], s80 offen sc1
    buffer_store_dwordx4 v[100:103], v13, s[48:51], s80 offen offset:1024 sc1
    s_waitcnt vmcnt(6)
    v_mov_b32 v3, 163780
    v_mov_b32 v4, 1
    s_mov_b64 exec, 1
    ds_add_rtn_u32 v5, v3, v4
    s_mov_b64 exec, -1
    s_waitcnt lgkmcnt(0)
    v_readfirstlane_b32 s3, v5
    s_nop 1
    s_cmp_lg_u32 s3, 7
    s_nop 0
    s_cbranch_scc1 L_SG14
    v_mov_b32 v4, 1
    s_mov_b64 exec, 1
    buffer_store_dword v4, v23, s[48:51], s11 offen offset:128 sc1
    s_mov_b64 exec, -1
L_SG14:
    s_mov_b32 s14, 0
    s_branch L_P2
L_ATT:
    ds_read_b128 v[128:131], v16 offset:0
    ds_read_b64_tr_b16 v[64:65], v11 offset:0
    ds_read_b64_tr_b16 v[66:67], v11 offset:512
    ds_read_b128 v[132:135], v17 offset:1024
    ds_read_b64_tr_b16 v[68:69], v11 offset:2048
    ds_read_b64_tr_b16 v[70:71], v11 offset:2560
    ds_read_b128 v[136:139], v18 offset:2048
    ds_read_b64_tr_b16 v[72:73], v11 offset:4096
    ds_read_b64_tr_b16 v[74:75], v11 offset:4608
    ds_read_b128 v[140:143], v19 offset:3072
    s_mul_i32 s3, s75, s87
    s_lshl_b32 s3, s3, 2
    s_add_u32 s6, s6, s3
    s_lshl_b32 s3, s75, 14
    s_add_u32 s3, s3, 57344
    s_add_u32 m0, s93, s3
    s_xor_b32 s3, s68, 4
    s_or_b32 s3, s3, s69
    s_cmp_lg_u32 s3, 0
    s_cbranch_scc1 L_ZF15
    v_mov_b32 v4, 1
    s_lshl_b32 s3, s70, 2
    buffer_store_dword v4, v23, s[52:55], s3 offen offset:0 sc1
L_ZF15:
    v_lshlrev_b32 v80, 16, v96
    v_and_b32 v81, s77, v96
    v_lshlrev_b32 v82, 16, v97
    v_and_b32 v83, s77, v97
    v_lshlrev_b32 v84, 16, v98
    v_and_b32 v85, s77, v98
    v_lshlrev_b32 v86, 16, v99
    v_and_b32 v87, s77, v99
    v_fma_f32 v80, v80, v28, v29
    v_fma_f32 v81, v81, v28, v29
    v_fma_f32 v82, v82, v28, v29
    v_fma_f32 v83, v83, v28, v29
    ds_read_b64_tr_b16 v[76:77], v11 offset:6144
    ds_read_b64_tr_b16 v[78:79], v11 offset:6656
    ds_read_b128 v[144:147], v16 offset:4096
    ds_read_b128 v[148:151], v17 offset:5120
    ds_read_b128 v[152:155], v18 offset:6144
    s_waitcnt lgkmcnt(12)
    v_mfma_f32_32x32x16_bf16 v[32:47], v[128:131], v[64:67], 0
    v_fma_f32 v84, v84, v28, v29
    v_fma_f32 v85, v85, v28, v29
    v_fma_f32 v86, v86, v28, v29
    v_fma_f32 v87, v87, v28, v29
    v_cvt_pk_bf16_f32 v96, v80, v81
    v_cvt_pk_bf16_f32 v97, v82, v83
    v_cvt_pk_bf16_f32 v98, v84, v85
    v_cvt_pk_bf16_f32 v99, v86, v87
    ds_read_b64_tr_b16 v[64:65], v11 offset:8192
    ds_read_b64_tr_b16 v[66:67], v11 offset:8704
    ds_read_b128 v[156:159], v19 offset:7168
    ds_read_b128 v[160:163], v16 offset:8192
    ds_read_b128 v[164:167], v17 offset:9216
    s_waitcnt lgkmcnt(14)
    v_mfma_f32_32x32x16_bf16 v[32:47], v[132:135], v[68:71], v[32:47]
    v_lshlrev_b32 v88, 16, v100
    v_and_b32 v89, s77, v100
    v_lshlrev_b32 v90, 16, v101
    v_and_b32 v91, s77, v101
    v_lshlrev_b32 v92, 16, v102
    v_and_b32 v93, s77, v102
    v_lshlrev_b32 v94, 16, v103
    v_and_b32 v95, s77, v103
    v_fma_f32 v88, v88, v30, v31
    buffer_load_dwordx4 v7, s[44:47], s6 offen lds
    s_add_u32 s6, s6, s87
    s_add_u32 m0, m0, 4096
    ds_read_b64_tr_b16 v[68:69], v11 offset:10240
    ds_read_b64_tr_b16 v[70:71], v11 offset:10752
    ds_read_b128 v[168:171], v18 offset:10240
    ds_read_b128 v[172:175], v19 offset:11264
    ds_read_b128 v[176:179], v16 offset:12288
    s_waitcnt lgkmcnt(15)
    v_mfma_f32_32x32x16_bf16 v[32:47], v[136:139], v[72:75], v[32:47]
    v_fma_f32 v89, v89, v30, v31
    v_fma_f32 v90, v90, v30, v31
    v_fma_f32 v91, v91, v30, v31
    v_fma_f32 v92, v92, v30, v31
    v_fma_f32 v93, v93, v30, v31
    v_fma_f32 v94, v94, v30, v31
    v_fma_f32 v95, v95, v30, v31
    v_cvt_pk_bf16_f32 v100, v88, v89
    v_cvt_pk_bf16_f32 v101, v90, v91
    ds_read_b64_tr_b16 v[72:73], v11 offset:12288
    ds_read_b64_tr_b16 v[74:75], v11 offset:12800
    ds_read_b128 v[180:183], v17 offset:13312
    ds_read_b128 v[184:187], v18 offset:14336
    ds_read_b128 v[188:191], v19 offset:15360
    s_waitcnt lgkmcnt(15)
    v_mfma_f32_32x32x16_bf16 v[32:47], v[140:143], v[76:79], v[32:47]
    v_cvt_pk_bf16_f32 v102, v92, v93
    v_cvt_pk_bf16_f32 v103, v94, v95
    v_lshlrev_b32 v80, 16, v104
    v_and_b32 v81, s77, v104
    v_lshlrev_b32 v82, 16, v105
    v_and_b32 v83, s77, v105
    v_lshlrev_b32 v84, 16, v106
    v_and_b32 v85, s77, v106
    buffer_load_dwordx4 v7, s[44:47], s6 offen lds
    s_add_u32 s6, s6, s87
    s_add_u32 m0, m0, 4096
    ds_read_b64_tr_b16 v[76:77], v11 offset:14336
    ds_read_b64_tr_b16 v[78:79], v11 offset:14848
    s_waitcnt lgkmcnt(15)
    v_mfma_f32_32x32x16_bf16 v[32:47], v[144:147], v[64:67], v[32:47]
    v_lshlrev_b32 v86, 16, v107
    v_and_b32 v87, s77, v107
    v_fma_f32 v80, v80, v28, v29
    v_fma_f32 v81, v81, v28, v29
    v_fma_f32 v82, v82, v28, v29
    v_fma_f32 v83, v83, v28, v29
    v_fma_f32 v84, v84, v28, v29
    v_fma_f32 v85, v85, v28, v29
    v_fma_f32 v86, v86, v28, v29
    s_waitcnt lgkmcnt(2)
    s_waitcnt vmcnt(9)
    s_barrier
    ds_read_b64_tr_b16 v[64:65], v11 offset:16384
    ds_read_b64_tr_b16 v[66:67], v11 offset:16896
    v_mfma_f32_32x32x16_bf16 v[32:47], v[148:151], v[68:71], v[32:47]
    v_fma_f32 v87, v87, v28, v29
    v_cvt_pk_bf16_f32 v104, v80, v81
    v_cvt_pk_bf16_f32 v105, v82, v83
    v_cvt_pk_bf16_f32 v106, v84, v85
    v_cvt_pk_bf16_f32 v107, v86, v87
    v_lshlrev_b32 v88, 16, v108
    v_and_b32 v89, s77, v108
    v_lshlrev_b32 v90, 16, v109
    ds_write_b128 v9, v[96:99] offset:0
    ds_write_b128 v9, v[100:103] offset:128
    ds_write_b128 v9, v[104:107] offset:4096
    ds_read_b64_tr_b16 v[68:69], v11 offset:18432
    ds_read_b64_tr_b16 v[70:71], v11 offset:18944
    v_mfma_f32_32x32x16_bf16 v[32:47], v[152:155], v[72:75], v[32:47]
    v_and_b32 v91, s77, v109
    v_lshlrev_b32 v92, 16, v110
    v_and_b32 v93, s77, v110
    v_lshlrev_b32 v94, 16, v111
    v_and_b32 v95, s77, v111
    v_fma_f32 v88, v88, v30, v31
    v_fma_f32 v89, v89, v30, v31
    v_fma_f32 v90, v90, v30, v31
    v_fma_f32 v91, v91, v30, v31
    buffer_load_dwordx4 v7, s[44:47], s6 offen lds
    s_add_u32 s6, s6, s87
    s_add_u32 m0, m0, 4096
    ds_read_b64_tr_b16 v[72:73], v11 offset:20480
    ds_read_b64_tr_b16 v[74:75], v11 offset:20992
    s_waitcnt lgkmcnt(9)
    v_mfma_f32_32x32x16_bf16 v[32:47], v[156:159], v[76:79], v[32:47]
    v_fma_f32 v92, v92, v30, v31
    v_fma_f32 v93, v93, v30, v31
    v_fma_f32 v94, v94, v30, v31
    v_fma_f32 v95, v95, v30, v31
    v_cvt_pk_bf16_f32 v108, v88, v89
    v_cvt_pk_bf16_f32 v109, v90, v91
    v_cvt_pk_bf16_f32 v110, v92, v93
    v_cvt_pk_bf16_f32 v111, v94, v95
    ds_write_b128 v9, v[108:111] offset:4224
    ds_read_b64_tr_b16 v[76:77], v11 offset:22528
    ds_read_b64_tr_b16 v[78:79], v11 offset:23040
    s_waitcnt lgkmcnt(10)
    v_mfma_f32_32x32x16_bf16 v[32:47], v[160:163], v[64:67], v[32:47]
    v_lshlrev_b32 v80, 16, v112
    v_and_b32 v81, s77, v112
    v_lshlrev_b32 v82, 16, v113
    v_and_b32 v83, s77, v113
    v_lshlrev_b32 v84, 16, v114
    v_and_b32 v85, s77, v114
    v_lshlrev_b32 v86, 16, v115
    v_and_b32 v87, s77, v115
    v_fma_f32 v80, v80, v28, v29
    s_cmp_eq_u32 s75, 0
    s_nop 0
    s_cbranch_scc0 L_C16
    buffer_load_dwordx4 v7, s[44:47], s6 offen lds
    s_add_u32 s6, s6, s87
    s_add_u32 m0, m0, 4096
L_C16:
    ds_read_b64_tr_b16 v[64:65], v11 offset:24576
    ds_read_b64_tr_b16 v[66:67], v11 offset:25088
    s_waitcnt lgkmcnt(7)
    v_mfma_f32_32x32x16_bf16 v[32:47], v[164:167], v[68:71], v[32:47]
    v_fma_f32 v81, v81, v28, v29
    v_fma_f32 v82, v82, v28, v29
    v_fma_f32 v83, v83, v28, v29
    v_fma_f32 v84, v84, v28, v29
    v_fma_f32 v85, v85, v28, v29
    v_fma_f32 v86, v86, v28, v29
    v_fma_f32 v87, v87, v28, v29
    v_cvt_pk_bf16_f32 v112, v80, v81
    v_cvt_pk_bf16_f32 v113, v82, v83
    s_cmp_eq_u32 s75, 1
    s_nop 0
    s_cbranch_scc0 L_C17
    s_cmp_lt_u32 s76, 2
    s_cselect_b64 s[64:65], s[28:29], s[20:21]
    s_cselect_b32 s73, 25, 7
    s_mov_b32 s66, 401408
    s_cselect_b32 s66, 1605632, s66
    s_and_b32 s3, s68, 1
    s_lshl_b32 s85, s2, 1
    s_add_u32 s3, s3, s85
    s_mul_i32 s3, s3, s73
    s_lshl_b32 s3, s3, 7
    v_lshlrev_b32 v5, 7, v1
    s_bfm_b64 exec, s73, 0
    buffer_load_dword v124, v5, s[64:67], s3 offen
    s_mov_b64 exec, -1
L_C17:
    ds_read_b64_tr_b16 v[68:69], v11 offset:26624
    ds_read_b64_tr_b16 v[70:71], v11 offset:27136
    s_waitcnt lgkmcnt(7)
    v_mfma_f32_32x32x16_bf16 v[32:47], v[168:171], v[72:75], v[32:47]
    v_cvt_pk_bf16_f32 v114, v84, v85
    v_cvt_pk_bf16_f32 v115, v86, v87
    v_lshlrev_b32 v88, 16, v116
    v_and_b32 v89, s77, v116
    v_lshlrev_b32 v90, 16, v117
    v_and_b32 v91, s77, v117
    v_lshlrev_b32 v92, 16, v118
    v_and_b32 v93, s77, v118
    ds_write_b128 v9, v[112:115] offset:8192
    s_waitcnt lgkmcnt(5)
    v_mfma_f32_32x32x16_bf16 v[32:47], v[172:175], v[76:79], v[32:47]
    v_lshlrev_b32 v94, 16, v119
    v_and_b32 v95, s77, v119
    v_fma_f32 v88, v88, v30, v31
    v_fma_f32 v89, v89, v30, v31
    v_fma_f32 v90, v90, v30, v31
    v_fma_f32 v91, v91, v30, v31
    v_fma_f32 v92, v92, v30, v31
    v_fma_f32 v93, v93, v30, v31
    v_fma_f32 v94, v94, v30, v31
    s_waitcnt lgkmcnt(3)
    v_mfma_f32_32x32x16_bf16 v[32:47], v[176:179], v[64:67], v[32:47]
    v_fma_f32 v95, v95, v30, v31
    v_cvt_pk_bf16_f32 v116, v88, v89
    v_cvt_pk_bf16_f32 v117, v90, v91
    v_cvt_pk_bf16_f32 v118, v92, v93
    v_cvt_pk_bf16_f32 v119, v94, v95
    ds_write_b128 v9, v[116:119] offset:8320
    s_waitcnt lgkmcnt(2)
    v_mfma_f32_32x32x16_bf16 v[32:47], v[180:183], v[68:71], v[32:47]
    s_waitcnt lgkmcnt(0)
    s_waitcnt vmcnt(4)
    s_barrier
    ds_read_b64_tr_b16 v[72:73], v12 offset:0
    ds_read_b64_tr_b16 v[74:75], v12 offset:512
    ds_read_b64_tr_b16 v[76:77], v12 offset:2048
    ds_read_b64_tr_b16 v[78:79], v12 offset:2560
    ds_read_b64_tr_b16 v[64:65], v12 offset:4096
    ds_read_b64_tr_b16 v[66:67], v12 offset:4608
    ds_read_b128 v[192:195], v16 offset:0
    ds_read_b128 v[196:199], v17 offset:1024
    ds_read_b128 v[200:203], v18 offset:2048
    ds_read_b128 v[204:207], v19 offset:3072
    ds_read_b128 v[208:211], v16 offset:4096
    ds_read_b128 v[212:215], v17 offset:5120
    ds_read_b64_tr_b16 v[68:69], v12 offset:6144
    ds_read_b64_tr_b16 v[70:71], v12 offset:6656
    s_waitcnt lgkmcnt(12)
    v_mfma_f32_32x32x16_bf16 v[32:47], v[184:187], v[72:75], v[32:47]
    ds_read_b64_tr_b16 v[72:73], v12 offset:8192
    ds_read_b64_tr_b16 v[74:75], v12 offset:8704
    s_waitcnt lgkmcnt(12)
    v_mfma_f32_32x32x16_bf16 v[32:47], v[188:191], v[76:79], v[32:47]
    ds_read_b128 v[216:219], v18 offset:6144
    ds_read_b128 v[220:223], v19 offset:7168
    ds_read_b128 v[224:227], v16 offset:8192
    ds_read_b128 v[228:231], v17 offset:9216
    ds_read_b128 v[232:235], v18 offset:10240
    ds_read_b128 v[236:239], v19 offset:11264
    ds_read_b64_tr_b16 v[76:77], v12 offset:10240
    ds_read_b64_tr_b16 v[78:79], v12 offset:10752
    s_waitcnt lgkmcnt(15)
    s_waitcnt lgkmcnt(15)
    v_mfma_f32_32x32x16_bf16 v[32:47], v[192:195], v[64:67], v[32:47]
    ds_read_b64_tr_b16 v[64:65], v12 offset:12288
    ds_read_b64_tr_b16 v[66:67], v12 offset:12800
    s_waitcnt lgkmcnt(12)
    v_mfma_f32_32x32x16_bf16 v[32:47], v[196:199], v[68:71], v[32:47]
    ds_read_b64_tr_b16 v[68:69], v12 offset:14336
    ds_read_b64_tr_b16 v[70:71], v12 offset:14848
    s_waitcnt lgkmcnt(12)
    v_mfma_f32_32x32x16_bf16 v[32:47], v[200:203], v[72:75], v[32:47]
    s_waitcnt lgkmcnt(6)
    s_barrier
    s_mul_i32 s3, s75, 344064
    s_add_u32 s7, s7, s3
    s_lshl_b32 s3, s75, 14
    s_add_u32 s3, s3, 86016
    s_add_u32 m0, s93, s3
    ds_read_b64_tr_b16 v[72:73], v12 offset:16384
    ds_read_b64_tr_b16 v[74:75], v12 offset:16896
    s_waitcnt lgkmcnt(6)
    v_mfma_f32_32x32x16_bf16 v[32:47], v[204:207], v[76:79], v[32:47]
    ds_read_b64_tr_b16 v[76:77], v12 offset:18432
    ds_read_b64_tr_b16 v[78:79], v12 offset:18944
    s_waitcnt lgkmcnt(6)
    v_mfma_f32_32x32x16_bf16 v[32:47], v[208:211], v[64:67], v[32:47]
    buffer_load_dwordx4 v7, s[44:47], s7 offen lds
    s_add_u32 s7, s7, 86016
    s_add_u32 m0, m0, 4096
    ds_read_b64_tr_b16 v[64:65], v12 offset:20480
    ds_read_b64_tr_b16 v[66:67], v12 offset:20992
    s_waitcnt lgkmcnt(6)
    v_mfma_f32_32x32x16_bf16 v[32:47], v[212:215], v[68:71], v[32:47]
    ds_read_b64_tr_b16 v[68:69], v12 offset:22528
    ds_read_b64_tr_b16 v[70:71], v12 offset:23040
    s_waitcnt lgkmcnt(6)
    v_mfma_f32_32x32x16_bf16 v[32:47], v[216:219], v[72:75], v[32:47]
    buffer_load_dwordx4 v7, s[44:47], s7 offen lds
    s_add_u32 s7, s7, 86016
    s_add_u32 m0, m0, 4096
    ds_read_b64_tr_b16 v[72:73], v12 offset:24576
    ds_read_b64_tr_b16 v[74:75], v12 offset:25088
    s_waitcnt lgkmcnt(6)
    v_mfma_f32_32x32x16_bf16 v[32:47], v[220:223], v[76:79], v[32:47]
    ds_read_b64_tr_b16 v[76:77], v12 offset:26624
    ds_read_b64_tr_b16 v[78:79], v12 offset:27136
    s_waitcnt lgkmcnt(6)
    v_mfma_f32_32x32x16_bf16 v[32:47], v[224:227], v[64:67], v[32:47]
    buffer_load_dwordx4 v7, s[44:47], s7 offen lds
    s_add_u32 s7, s7, 86016
    s_add_u32 m0, m0, 4096
    s_waitcnt lgkmcnt(4)
    v_mfma_f32_32x32x16_bf16 v[32:47], v[228:231], v[68:71], v[32:47]
    v_and_b32 v2, 31, v1
    v_cmp_gt_u32 s[98:99], 28, v2
    v_cmp_eq_u32 vcc, 28, v2
    v_mov_b32 v3, s78
    v_cndmask_b32 v21, 0, -1, s[98:99]
    v_cndmask_b32 v22, 0, v3, vcc
    v_cmp_gt_u32 vcc, 32, v1
    s_nop 1
    v_cndmask_b32 v20, 0, -1, vcc
    s_mov_b32 s79, 0x3fb8aa3b
    s_mov_b32 s80, 0x358637bd
    v_add_u32 v11, 57344, v10
    v_add_u32 v12, 86016, v10
    s_waitcnt lgkmcnt(2)
    v_mfma_f32_32x32x16_bf16 v[32:47], v[232:235], v[72:75], v[32:47]
    s_cmp_eq_u32 s75, 0
    s_nop 9
    s_cbranch_scc0 L_C18
    buffer_load_dwordx4 v7, s[44:47], s7 offen lds
    s_add_u32 s7, s7, 86016
    s_add_u32 m0, m0, 4096
L_C18:
    s_waitcnt lgkmcnt(0)
    v_mfma_f32_32x32x16_bf16 v[104:119], v[236:239], v[76:79], v[32:47]
    s_mov_b64 s[64:65], s[44:45]
    s_mov_b32 s66, s46
    s_mov_b32 s87, 86016
    s_mov_b32 s3, 114688
    s_mov_b32 s86, s8
    s_cmp_eq_u32 s75, 0
    s_cselect_b32 s3, 0, s3
    s_cselect_b32 s86, s9, s86
    v_mov_b32 v122, v7
    s_add_u32 m0, s93, s3
    s_waitcnt vmcnt(3)
    s_barrier
    ds_read_b64_tr_b16 v[64:65], v11 offset:0
    ds_read_b64_tr_b16 v[66:67], v11 offset:512
    ds_read_b64_tr_b16 v[68:69], v11 offset:2048
    ds_read_b64_tr_b16 v[70:71], v11 offset:2560
    ds_read_b64_tr_b16 v[72:73], v11 offset:4096
    ds_read_b64_tr_b16 v[74:75], v11 offset:4608
    v_mul_f32 v80, s79, v104
    v_mul_f32 v81, s79, v105
    v_mul_f32 v82, s79, v106
    v_mul_f32 v83, s79, v107
    v_mul_f32 v84, s79, v108
    v_mul_f32 v85, s79, v109
    v_mul_f32 v86, s79, v110
    v_mul_f32 v87, s79, v111
    v_mul_f32 v88, s79, v112
    v_mul_f32 v89, s79, v113
    v_mul_f32 v90, s79, v114
    v_mul_f32 v91, s79, v115
    v_mul_f32 v92, s79, v116
    v_mul_f32 v93, s79, v117
    v_mul_f32 v94, s79, v118
    v_mul_f32 v95, s79, v119
    v_exp_f32 v80, v80 clamp
    v_exp_f32 v81, v81 clamp
    v_exp_f32 v82, v82 clamp
    s_setprio 1
    ds_read_b64_tr_b16 v[76:77], v11 offset:6144
    ds_read_b64_tr_b16 v[78:79], v11 offset:6656
    s_waitcnt lgkmcnt(6)
    v_mfma_f32_32x32x16_bf16 v[32:47], v[128:131], v[64:67], 0
    buffer_load_dwordx4 v122, s[64:67], s86 offen lds
    ds_read_b64_tr_b16 v[64:65], v11 offset:8192
    ds_read_b64_tr_b16 v[66:67], v11 offset:8704
    s_waitcnt lgkmcnt(6)
    v_mfma_f32_32x32x16_bf16 v[32:47], v[132:135], v[68:71], v[32:47]
    s_add_u32 m0, m0, 4096
    s_add_u32 s86, s86, s87
    ds_read_b64_tr_b16 v[68:69], v11 offset:10240
    ds_read_b64_tr_b16 v[70:71], v11 offset:10752
    s_waitcnt lgkmcnt(6)
    v_mfma_f32_32x32x16_bf16 v[32:47], v[136:139], v[72:75], v[32:47]
    s_cmp_lg_u32 s68, 7
    s_nop 9
    s_cbranch_scc1 L_W719
    v_lshlrev_b32 v3, 2, v1
    s_mov_b64 exec, 0xffffffff
    buffer_load_dword v120, v3, s[52:55], 0 offen sc1
    s_mov_b64 exec, -1
L_W719:
    ds_read_b64_tr_b16 v[72:73], v11 offset:12288
    ds_read_b64_tr_b16 v[74:75], v11 offset:12800
    s_waitcnt lgkmcnt(6)
    v_mfma_f32_32x32x16_bf16 v[32:47], v[140:143], v[76:79], v[32:47]
    ds_read_b64_tr_b16 v[76:77], v11 offset:14336
    ds_read_b64_tr_b16 v[78:79], v11 offset:14848
    s_waitcnt lgkmcnt(6)
    v_mfma_f32_32x32x16_bf16 v[32:47], v[144:147], v[64:67], v[32:47]
    buffer_load_dwordx4 v122, s[64:67], s86 offen lds
    ds_read_b64_tr_b16 v[64:65], v11 offset:16384
    ds_read_b64_tr_b16 v[66:67], v11 offset:16896
    s_waitcnt lgkmcnt(6)
    v_mfma_f32_32x32x16_bf16 v[32:47], v[148:151], v[68:71], v[32:47]
    s_add_u32 m0, m0, 4096
    s_add_u32 s86, s86, s87
    ds_read_b64_tr_b16 v[68:69], v11 offset:18432
    ds_read_b64_tr_b16 v[70:71], v11 offset:18944
    s_waitcnt lgkmcnt(6)
    v_mfma_f32_32x32x16_bf16 v[32:47], v[152:155], v[72:75], v[32:47]
    s_setprio 0
    v_exp_f32 v83, v83 clamp
    v_exp_f32 v84, v84 clamp
    v_exp_f32 v85, v85 clamp
    v_exp_f32 v86, v86 clamp
    v_exp_f32 v87, v87 clamp
    v_exp_f32 v88, v88 clamp
    v_exp_f32 v89, v89 clamp
    v_exp_f32 v90, v90 clamp
    v_exp_f32 v91, v91 clamp
    v_exp_f32 v92, v92 clamp
    v_exp_f32 v93, v93 clamp
    s_setprio 1
    ds_read_b64_tr_b16 v[72:73], v11 offset:20480
    ds_read_b64_tr_b16 v[74:75], v11 offset:20992
    s_waitcnt lgkmcnt(6)
    v_mfma_f32_32x32x16_bf16 v[32:47], v[156:159], v[76:79], v[32:47]
    ds_read_b64_tr_b16 v[76:77], v11 offset:22528
    ds_read_b64_tr_b16 v[78:79], v11 offset:23040
    s_waitcnt lgkmcnt(6)
    v_mfma_f32_32x32x16_bf16 v[32:47], v[160:163], v[64:67], v[32:47]
    buffer_load_dwordx4 v122, s[64:67], s86 offen lds
    ds_read_b64_tr_b16 v[64:65], v11 offset:24576
    ds_read_b64_tr_b16 v[66:67], v11 offset:25088
    s_waitcnt lgkmcnt(6)
    v_mfma_f32_32x32x16_bf16 v[32:47], v[164:167], v[68:71], v[32:47]
    s_add_u32 m0, m0, 4096
    s_add_u32 s86, s86, s87
    ds_read_b64_tr_b16 v[68:69], v11 offset:26624
    ds_read_b64_tr_b16 v[70:71], v11 offset:27136
    s_waitcnt lgkmcnt(6)
    v_mfma_f32_32x32x16_bf16 v[32:47], v[168:171], v[72:75], v[32:47]
    s_waitcnt vmcnt(3)
    s_barrier
    ds_read_b64_tr_b16 v[72:73], v12 offset:0
    ds_read_b64_tr_b16 v[74:75], v12 offset:512
    s_waitcnt lgkmcnt(6)
    v_mfma_f32_32x32x16_bf16 v[32:47], v[172:175], v[76:79], v[32:47]
    ds_read_b64_tr_b16 v[76:77], v12 offset:2048
    ds_read_b64_tr_b16 v[78:79], v12 offset:2560
    s_waitcnt lgkmcnt(6)
    v_mfma_f32_32x32x16_bf16 v[32:47], v[176:179], v[64:67], v[32:47]
    buffer_load_dwordx4 v122, s[64:67], s86 offen lds
    ds_read_b64_tr_b16 v[64:65], v12 offset:4096
    ds_read_b64_tr_b16 v[66:67], v12 offset:4608
    s_waitcnt lgkmcnt(6)
    v_mfma_f32_32x32x16_bf16 v[32:47], v[180:183], v[68:71], v[32:47]
    s_add_u32 m0, m0, 4096
    s_add_u32 s86, s86, s87
    s_setprio 0
    v_exp_f32 v94, v94 clamp
    v_exp_f32 v95, v95 clamp
    v_max_f32 v104, s80, v104
    v_max_f32 v105, s80, v105
    v_max_f32 v106, s80, v106
    v_max_f32 v107, s80, v107
    v_max_f32 v108, s80, v108
    v_max_f32 v109, s80, v109
    v_max_f32 v110, s80, v110
    v_max_f32 v111, s80, v111
    v_max_f32 v112, s80, v112
    v_max_f32 v113, s80, v113
    v_max_f32 v114, s80, v114
    v_max_f32 v115, s80, v115
    v_max_f32 v116, s80, v116
    v_max_f32 v117, s80, v117
    v_max_f32 v118, s80, v118
    v_max_f32 v119, s80, v119
    v_add_f32 v80, v80, v104
    v_add_f32 v81, v81, v105
    s_setprio 1
    ds_read_b64_tr_b16 v[68:69], v12 offset:6144
    ds_read_b64_tr_b16 v[70:71], v12 offset:6656
    s_waitcnt lgkmcnt(6)
    v_mfma_f32_32x32x16_bf16 v[32:47], v[184:187], v[72:75], v[32:47]
    ds_read_b64_tr_b16 v[72:73], v12 offset:8192
    ds_read_b64_tr_b16 v[74:75], v12 offset:8704
    s_waitcnt lgkmcnt(6)
    v_mfma_f32_32x32x16_bf16 v[32:47], v[188:191], v[76:79], v[32:47]
    ds_read_b64_tr_b16 v[76:77], v12 offset:10240
    ds_read_b64_tr_b16 v[78:79], v12 offset:10752
    s_waitcnt lgkmcnt(6)
    v_mfma_f32_32x32x16_bf16 v[32:47], v[192:195], v[64:67], v[32:47]
    buffer_load_dwordx4 v122, s[64:67], s86 offen lds
    ds_read_b64_tr_b16 v[64:65], v12 offset:12288
    ds_read_b64_tr_b16 v[66:67], v12 offset:12800
    s_waitcnt lgkmcnt(6)
    v_mfma_f32_32x32x16_bf16 v[32:47], v[196:199], v[68:71], v[32:47]
    s_add_u32 m0, m0, 4096
    s_add_u32 s86, s86, s87
    ds_read_b64_tr_b16 v[68:69], v12 offset:14336
    ds_read_b64_tr_b16 v[70:71], v12 offset:14848
    s_waitcnt lgkmcnt(6)
    v_mfma_f32_32x32x16_bf16 v[32:47], v[200:203], v[72:75], v[32:47]
    ds_read_b64_tr_b16 v[72:73], v12 offset:16384
    ds_read_b64_tr_b16 v[74:75], v12 offset:16896
    s_waitcnt lgkmcnt(6)
    v_mfma_f32_32x32x16_bf16 v[32:47], v[204:207], v[76:79], v[32:47]
    ds_read_b64_tr_b16 v[76:77], v12 offset:18432
    ds_read_b64_tr_b16 v[78:79], v12 offset:18944
    s_waitcnt lgkmcnt(6)
    v_mfma_f32_32x32x16_bf16 v[32:47], v[208:211], v[64:67], v[32:47]
    buffer_load_dwordx4 v122, s[64:67], s86 offen lds
    s_setprio 0
    v_add_f32 v82, v82, v106
    v_add_f32 v83, v83, v107
    v_add_f32 v84, v84, v108
    v_add_f32 v85, v85, v109
    v_add_f32 v86, v86, v110
    v_add_f32 v87, v87, v111
    v_add_f32 v88, v88, v112
    v_add_f32 v89, v89, v113
    v_add_f32 v90, v90, v114
    v_add_f32 v91, v91, v115
    v_add_f32 v92, v92, v116
    v_add_f32 v93, v93, v117
    v_add_f32 v94, v94, v118
    v_add_f32 v95, v95, v119
    v_cvt_pk_bf16_f32 v96, v80, v81
    v_cvt_pk_bf16_f32 v97, v82, v83
    v_cvt_pk_bf16_f32 v98, v84, v85
    v_cvt_pk_bf16_f32 v99, v86, v87
    v_cvt_pk_bf16_f32 v100, v88, v89
    v_cvt_pk_bf16_f32 v101, v90, v91
    v_cvt_pk_bf16_f32 v102, v92, v93
    v_cvt_pk_bf16_f32 v103, v94, v95
    s_lshl_b32 s73, s83, 10
    s_lshl_b32 s22, s83, 11
    s_mul_i32 s98, s83, 14336
    s_lshr_b32 s3, s83, 1
    s_mul_i32 s89, s3, 25088
    s_and_b32 s3, s83, 1
    s_mul_i32 s3, s3, 14336
    s_add_u32 s89, s89, s3
    s_sub_u32 s82, s95, s73
    s_lshl_b32 s3, s76, 10
    s_add_u32 s82, s82, s3
    s_lshl_b32 s3, s75, 15
    s_add_u32 s82, s82, s3
    s_mul_i32 s100, s76, 14336
    s_add_u32 s100, s100, 1376256
    s_lshr_b32 s3, s76, 1
    s_mul_i32 s101, s3, 25088
    s_and_b32 s3, s76, 1
    s_mul_i32 s3, s3, 14336
    s_add_u32 s101, s101, s3
    s_add_u32 s101, s101, 200704
    s_cmp_eq_u32 s75, 0
    s_cselect_b32 s100, s100, s101
    s_mov_b32 s101, 50176
    s_cselect_b32 s101, 57344, s101
    v_lshlrev_b32 v19, 9, v1
    v_and_b32 v2, 3, v1
    v_lshlrev_b32 v2, 3, v2
    v_and_b32 v3, 16, v1
    v_lshl_add_u32 v2, v3, 1, v2
    v_and_b32 v3, 8, v1
    v_lshl_add_u32 v2, v3, 3, v2
    v_and_b32 v3, 12, v1
    v_lshl_add_u32 v2, v3, 5, v2
    v_lshrrev_b32 v4, 5, v1
    v_lshl_add_u32 v18, v4, 9, v2
    v_add_u32 v18, s22, v18
    v_add_u32 v9, 147456, v13
    s_setprio 1
    ds_read_b64_tr_b16 v[64:65], v12 offset:20480
    ds_read_b64_tr_b16 v[66:67], v12 offset:20992
    s_waitcnt lgkmcnt(6)
    v_mfma_f32_32x32x16_bf16 v[32:47], v[212:215], v[68:71], v[32:47]
    s_add_u32 m0, m0, 4096
    s_add_u32 s86, s86, s87
    ds_read_b64_tr_b16 v[68:69], v12 offset:22528
    ds_read_b64_tr_b16 v[70:71], v12 offset:23040
    s_waitcnt lgkmcnt(6)
    v_mfma_f32_32x32x16_bf16 v[32:47], v[216:219], v[72:75], v[32:47]
    ds_read_b64_tr_b16 v[72:73], v12 offset:24576
    ds_read_b64_tr_b16 v[74:75], v12 offset:25088
    s_waitcnt lgkmcnt(6)
    v_mfma_f32_32x32x16_bf16 v[32:47], v[220:223], v[76:79], v[32:47]
    ds_read_b64_tr_b16 v[76:77], v12 offset:26624
    ds_read_b64_tr_b16 v[78:79], v12 offset:27136
    s_waitcnt lgkmcnt(6)
    v_mfma_f32_32x32x16_bf16 v[32:47], v[224:227], v[64:67], v[32:47]
    buffer_load_dwordx4 v122, s[64:67], s86 offen lds
    s_waitcnt lgkmcnt(4)
    v_mfma_f32_32x32x16_bf16 v[32:47], v[228:231], v[68:71], v[32:47]
    s_waitcnt lgkmcnt(2)
    v_mfma_f32_32x32x16_bf16 v[32:47], v[232:235], v[72:75], v[32:47]
    s_cmp_lg_u32 s68, 7
    s_nop 9
    s_cbranch_scc1 L_W720
    s_waitcnt vmcnt(2)
    s_mov_b32 s85, 0
L_FC21:
    v_cmp_ne_u32 vcc, 0, v120
    s_nop 1
    s_and_b32 s3, vcc_lo, 0xffff00ff
    s_cmp_eq_u32 s3, 0xffff00ff
    s_cbranch_scc1 L_FD22
    s_add_u32 s85, s85, 1
    s_cmp_gt_u32 s85, 200000
    s_cbranch_scc1 L_FD22
    v_lshlrev_b32 v3, 2, v1
    s_mov_b64 exec, 0xffffffff
    buffer_load_dword v120, v3, s[52:55], 0 offen sc1
    s_mov_b64 exec, -1
    s_waitcnt vmcnt(0)
    s_branch L_FC21
L_FD22:
L_W720:
    s_waitcnt lgkmcnt(0)
    v_mfma_f32_32x32x16_bf16 v[104:119], v[236:239], v[76:79], v[32:47]
    s_setprio 0
    s_nop 10
    v_cvt_pk_bf16_f32 v80, v104, v105
    v_cvt_pk_bf16_f32 v81, v106, v107
    v_cvt_pk_bf16_f32 v82, v108, v109
    v_cvt_pk_bf16_f32 v83, v110, v111
    v_cvt_pk_bf16_f32 v84, v112, v113
    v_cvt_pk_bf16_f32 v85, v114, v115
    v_cvt_pk_bf16_f32 v86, v116, v117
    v_cvt_pk_bf16_f32 v87, v118, v119
    v_and_or_b32 v80, v80, v21, v22
    v_and_or_b32 v81, v81, v21, v22
    v_and_or_b32 v82, v82, v21, v22
    v_and_or_b32 v83, v83, v21, v22
    v_and_or_b32 v84, v84, v21, v22
    v_and_or_b32 v85, v85, v21, v22
    v_and_or_b32 v86, v86, v21, v22
    v_and_or_b32 v87, v87, v21, v22
    v_mfma_f32_32x32x16_bf16 v[32:47], v[96:99], v[80:83], 0
    s_nop 0
    v_mfma_f32_32x32x16_bf16 v[32:47], v[100:103], v[84:87], v[32:47]
    s_mul_i32 s73, s75, 114688
    s_add_u32 s73, s73, 28672
    s_lshl_b32 s3, s76, 10
    s_add_u32 s3, s3, s73
    v_add_u32 v3, s3, v13
    s_lshl_b32 s3, s76, 12
    s_add_u32 s3, s3, s73
    v_add_u32 v5, s3, v13
    s_nop 3
    ds_write_b128 v3, v[32:35] offset:0
    ds_write_b128 v3, v[36:39] offset:4096
    ds_write_b128 v3, v[40:43] offset:8192
    ds_write_b128 v3, v[44:47] offset:12288
    s_waitcnt lgkmcnt(0)
    s_barrier
    ds_read_b128 v[80:83], v5 offset:0
    ds_read_b128 v[84:87], v5 offset:1024
    ds_read_b128 v[88:91], v5 offset:2048
    ds_read_b128 v[92:95], v5 offset:3072
    s_lshl_b32 s3, s84, 12
    s_lshl_b32 s73, s76, 10
    s_add_u32 s73, s3, s73
    s_add_u32 s73, s73, 10485760
    v_lshlrev_b32 v2, 2, v1
    v_add_u32 v11, 114688, v10
    v_add_u32 v12, 0, v10
    s_waitcnt lgkmcnt(0)
    v_add_f32 v80, v80, v84
    v_add_f32 v88, v88, v92
    v_add_f32 v81, v81, v85
    v_add_f32 v89, v89, v93
    v_add_f32 v82, v82, v86
    v_add_f32 v90, v90, v94
    v_add_f32 v83, v83, v87
    v_add_f32 v91, v91, v95
    v_add_f32 v80, v80, v88
    v_add_f32 v81, v81, v89
    v_add_f32 v82, v82, v90
    v_add_f32 v83, v83, v91
    buffer_atomic_add_f32 v80, v2, s[48:51], s73 offen offset:0
    buffer_atomic_add_f32 v81, v2, s[48:51], s73 offen offset:256
    buffer_atomic_add_f32 v82, v2, s[48:51], s73 offen offset:512
    buffer_atomic_add_f32 v83, v2, s[48:51], s73 offen offset:768
    s_waitcnt vmcnt(4)
    s_barrier
    ds_read_b64_tr_b16 v[64:65], v11 offset:0
    ds_read_b64_tr_b16 v[66:67], v11 offset:512
    ds_read_b64_tr_b16 v[68:69], v11 offset:2048
    ds_read_b64_tr_b16 v[70:71], v11 offset:2560
    ds_read_b64_tr_b16 v[72:73], v11 offset:4096
    ds_read_b64_tr_b16 v[74:75], v11 offset:4608
    ds_read_b64_tr_b16 v[76:77], v11 offset:6144
    ds_read_b64_tr_b16 v[78:79], v11 offset:6656
    s_waitcnt lgkmcnt(6)
    v_mfma_f32_32x32x16_bf16 v[32:47], v[64:67], v[128:131], 0
    s_add_u32 m0, s22, 28672
    s_add_u32 s3, s98, 0
    buffer_load_dwordx4 v6, s[56:59], s3 offen lds
    ds_read_b64_tr_b16 v[64:65], v11 offset:8192
    ds_read_b64_tr_b16 v[66:67], v11 offset:8704
    s_waitcnt lgkmcnt(6)
    v_mfma_f32_32x32x16_bf16 v[32:47], v[68:71], v[132:135], v[32:47]
    ds_read_b64_tr_b16 v[68:69], v11 offset:10240
    ds_read_b64_tr_b16 v[70:71], v11 offset:10752
    s_waitcnt lgkmcnt(6)
    v_mfma_f32_32x32x16_bf16 v[32:47], v[72:75], v[136:139], v[32:47]
    s_add_u32 m0, s22, 29696
    s_add_u32 s3, s98, 7168
    buffer_load_dwordx4 v6, s[56:59], s3 offen lds
    ds_read_b64_tr_b16 v[72:73], v11 offset:12288
    ds_read_b64_tr_b16 v[74:75], v11 offset:12800
    s_waitcnt lgkmcnt(6)
    v_mfma_f32_32x32x16_bf16 v[32:47], v[76:79], v[140:143], v[32:47]
    ds_read_b64_tr_b16 v[76:77], v11 offset:14336
    ds_read_b64_tr_b16 v[78:79], v11 offset:14848
    s_waitcnt lgkmcnt(6)
    v_mfma_f32_32x32x16_bf16 v[32:47], v[64:67], v[144:147], v[32:47]
    ds_read_b64_tr_b16 v[64:65], v11 offset:16384
    ds_read_b64_tr_b16 v[66:67], v11 offset:16896
    s_waitcnt lgkmcnt(6)
    v_mfma_f32_32x32x16_bf16 v[32:47], v[68:71], v[148:151], v[32:47]
    s_add_u32 m0, s22, 45056
    s_add_u32 s3, s98, 114688
    buffer_load_dwordx4 v6, s[56:59], s3 offen lds
    ds_read_b64_tr_b16 v[68:69], v11 offset:18432
    ds_read_b64_tr_b16 v[70:71], v11 offset:18944
    s_waitcnt lgkmcnt(6)
    v_mfma_f32_32x32x16_bf16 v[32:47], v[72:75], v[152:155], v[32:47]
    ds_read_b64_tr_b16 v[72:73], v11 offset:20480
    ds_read_b64_tr_b16 v[74:75], v11 offset:20992
    s_waitcnt lgkmcnt(6)
    v_mfma_f32_32x32x16_bf16 v[32:47], v[76:79], v[156:159], v[32:47]
    s_add_u32 m0, s22, 46080
    s_add_u32 s3, s98, 121856
    buffer_load_dwordx4 v6, s[56:59], s3 offen lds
    ds_read_b64_tr_b16 v[76:77], v11 offset:22528
    ds_read_b64_tr_b16 v[78:79], v11 offset:23040
    s_waitcnt lgkmcnt(6)
    v_mfma_f32_32x32x16_bf16 v[32:47], v[64:67], v[160:163], v[32:47]
    ds_read_b64_tr_b16 v[64:65], v11 offset:24576
    ds_read_b64_tr_b16 v[66:67], v11 offset:25088
    s_waitcnt lgkmcnt(6)
    v_mfma_f32_32x32x16_bf16 v[32:47], v[68:71], v[164:167], v[32:47]
    ds_read_b64_tr_b16 v[68:69], v11 offset:26624
    ds_read_b64_tr_b16 v[70:71], v11 offset:27136
    s_waitcnt lgkmcnt(6)
    v_mfma_f32_32x32x16_bf16 v[32:47], v[72:75], v[168:171], v[32:47]
    s_add_u32 m0, s22, 61440
    s_add_u32 s3, s98, 229376
    buffer_load_dwordx4 v6, s[56:59], s3 offen lds
    ds_read_b64_tr_b16 v[72:73], v12 offset:0
    ds_read_b64_tr_b16 v[74:75], v12 offset:512
    s_waitcnt lgkmcnt(6)
    v_mfma_f32_32x32x16_bf16 v[32:47], v[76:79], v[172:175], v[32:47]
    ds_read_b64_tr_b16 v[76:77], v12 offset:2048
    ds_read_b64_tr_b16 v[78:79], v12 offset:2560
    s_waitcnt lgkmcnt(6)
    v_mfma_f32_32x32x16_bf16 v[32:47], v[64:67], v[176:179], v[32:47]
    s_add_u32 m0, s22, 62464
    s_add_u32 s3, s98, 236544
    buffer_load_dwordx4 v6, s[56:59], s3 offen lds
    ds_read_b64_tr_b16 v[64:65], v12 offset:4096
    ds_read_b64_tr_b16 v[66:67], v12 offset:4608
    s_waitcnt lgkmcnt(6)
    v_mfma_f32_32x32x16_bf16 v[32:47], v[68:71], v[180:183], v[32:47]
    ds_read_b64_tr_b16 v[68:69], v12 offset:6144
    ds_read_b64_tr_b16 v[70:71], v12 offset:6656
    s_waitcnt lgkmcnt(6)
    v_mfma_f32_32x32x16_bf16 v[32:47], v[72:75], v[184:187], v[32:47]
    ds_read_b64_tr_b16 v[72:73], v12 offset:8192
    ds_read_b64_tr_b16 v[74:75], v12 offset:8704
    s_waitcnt lgkmcnt(6)
    v_mfma_f32_32x32x16_bf16 v[32:47], v[76:79], v[188:191], v[32:47]
    s_add_u32 m0, s22, 77824
    s_add_u32 s3, s98, 344064
    buffer_load_dwordx4 v6, s[56:59], s3 offen lds
    ds_read_b64_tr_b16 v[76:77], v12 offset:10240
    ds_read_b64_tr_b16 v[78:79], v12 offset:10752
    s_waitcnt lgkmcnt(6)
    v_mfma_f32_32x32x16_bf16 v[32:47], v[64:67], v[192:195], v[32:47]
    ds_read_b64_tr_b16 v[64:65], v12 offset:12288
    ds_read_b64_tr_b16 v[66:67], v12 offset:12800
    s_waitcnt lgkmcnt(6)
    v_mfma_f32_32x32x16_bf16 v[32:47], v[68:71], v[196:199], v[32:47]
    s_add_u32 m0, s22, 78848
    s_add_u32 s3, s98, 351232
    buffer_load_dwordx4 v6, s[56:59], s3 offen lds
    ds_read_b64_tr_b16 v[68:69], v12 offset:14336
    ds_read_b64_tr_b16 v[70:71], v12 offset:14848
    s_waitcnt lgkmcnt(6)
    v_mfma_f32_32x32x16_bf16 v[32:47], v[72:75], v[200:203], v[32:47]
    ds_read_b64_tr_b16 v[72:73], v12 offset:16384
    ds_read_b64_tr_b16 v[74:75], v12 offset:16896
    s_waitcnt lgkmcnt(6)
    v_mfma_f32_32x32x16_bf16 v[32:47], v[76:79], v[204:207], v[32:47]
    ds_read_b64_tr_b16 v[76:77], v12 offset:18432
    ds_read_b64_tr_b16 v[78:79], v12 offset:18944
    s_waitcnt lgkmcnt(6)
    v_mfma_f32_32x32x16_bf16 v[32:47], v[64:67], v[208:211], v[32:47]
    s_add_u32 m0, s22, 94208
    s_add_u32 s3, s98, 458752
    buffer_load_dwordx4 v6, s[56:59], s3 offen lds
    ds_read_b64_tr_b16 v[64:65], v12 offset:20480
    ds_read_b64_tr_b16 v[66:67], v12 offset:20992
    s_waitcnt lgkmcnt(6)
    v_mfma_f32_32x32x16_bf16 v[32:47], v[68:71], v[212:215], v[32:47]
    ds_read_b64_tr_b16 v[68:69], v12 offset:22528
    ds_read_b64_tr_b16 v[70:71], v12 offset:23040
    s_waitcnt lgkmcnt(6)
    v_mfma_f32_32x32x16_bf16 v[32:47], v[72:75], v[216:219], v[32:47]
    s_add_u32 m0, s22, 95232
    s_add_u32 s3, s98, 465920
    buffer_load_dwordx4 v6, s[56:59], s3 offen lds
    ds_read_b64_tr_b16 v[72:73], v12 offset:24576
    ds_read_b64_tr_b16 v[74:75], v12 offset:25088
    s_waitcnt lgkmcnt(6)
    v_mfma_f32_32x32x16_bf16 v[32:47], v[76:79], v[220:223], v[32:47]
    ds_read_b64_tr_b16 v[76:77], v12 offset:26624
    ds_read_b64_tr_b16 v[78:79], v12 offset:27136
    s_waitcnt lgkmcnt(6)
    v_mfma_f32_32x32x16_bf16 v[32:47], v[64:67], v[224:227], v[32:47]
    s_waitcnt lgkmcnt(4)
    v_mfma_f32_32x32x16_bf16 v[32:47], v[68:71], v[228:231], v[32:47]
    s_waitcnt lgkmcnt(2)
    v_mfma_f32_32x32x16_bf16 v[32:47], v[72:75], v[232:235], v[32:47]
    s_waitcnt lgkmcnt(0)
    v_mfma_f32_32x32x16_bf16 v[104:119], v[76:79], v[236:239], v[32:47]
    s_waitcnt vmcnt(10)
    s_barrier
    s_setprio 3
    s_cmp_lg_u32 s68, 0
    s_nop 6
    s_cbranch_scc1 L_KS23
    v_mov_b32 v4, 1
    s_mov_b64 exec, 1
    buffer_store_dword v4, v23, s[48:51], s11 offen offset:0 sc1
    s_mov_b64 exec, -1
L_KS23:
    s_cmp_lg_u32 s68, 0
    s_cbranch_scc1 L_PI24
    s_mov_b64 exec, 65280
    buffer_load_dword v248, v19, s[48:51], s13 offen offset:0 sc1
    s_mov_b64 exec, -1
L_PI24:
    s_add_u32 m0, s22, 114688
    s_add_u32 s3, s98, 573440
    buffer_load_dwordx4 v6, s[56:59], s3 offen lds
    s_add_u32 m0, s22, 115712
    s_add_u32 s3, s98, 580608
    buffer_load_dwordx4 v6, s[56:59], s3 offen lds
    s_add_u32 m0, s22, 131072
    s_add_u32 s3, s98, 688128
    buffer_load_dwordx4 v6, s[56:59], s3 offen lds
    s_add_u32 m0, s22, 132096
    s_add_u32 s3, s98, 695296
    buffer_load_dwordx4 v6, s[56:59], s3 offen lds
    v_mul_f32 v80, s79, v104
    v_mul_f32 v81, s79, v105
    v_mul_f32 v82, s79, v106
    v_mul_f32 v83, s79, v107
    v_mul_f32 v84, s79, v108
    v_mul_f32 v85, s79, v109
    v_mul_f32 v86, s79, v110
    v_mul_f32 v87, s79, v111
    v_mul_f32 v88, s79, v112
    v_mul_f32 v89, s79, v113
    v_mul_f32 v90, s79, v114
    v_mul_f32 v91, s79, v115
    v_mul_f32 v92, s79, v116
    v_mul_f32 v93, s79, v117
    v_mul_f32 v94, s79, v118
    v_mul_f32 v95, s79, v119
    v_exp_f32 v80, v80 clamp
    v_exp_f32 v81, v81 clamp
    v_exp_f32 v82, v82 clamp
    v_exp_f32 v83, v83 clamp
    v_exp_f32 v84, v84 clamp
    v_exp_f32 v85, v85 clamp
    v_exp_f32 v86, v86 clamp
    v_exp_f32 v87, v87 clamp
    v_exp_f32 v88, v88 clamp
    v_exp_f32 v89, v89 clamp
    v_exp_f32 v90, v90 clamp
    v_exp_f32 v91, v91 clamp
    v_exp_f32 v92, v92 clamp
    v_exp_f32 v93, v93 clamp
    v_exp_f32 v94, v94 clamp
    v_exp_f32 v95, v95 clamp
    v_max_f32 v104, s80, v104
    v_max_f32 v105, s80, v105
    v_max_f32 v106, s80, v106
    v_max_f32 v107, s80, v107
    v_max_f32 v108, s80, v108
    v_max_f32 v109, s80, v109
    v_max_f32 v110, s80, v110
    v_max_f32 v111, s80, v111
    v_max_f32 v112, s80, v112
    v_max_f32 v113, s80, v113
    v_max_f32 v114, s80, v114
    v_max_f32 v115, s80, v115
    v_max_f32 v116, s80, v116
    v_max_f32 v117, s80, v117
    v_max_f32 v118, s80, v118
    v_max_f32 v119, s80, v119
    v_add_f32 v80, v80, v104
    v_add_f32 v81, v81, v105
    v_add_f32 v82, v82, v106
    v_add_f32 v83, v83, v107
    v_add_f32 v84, v84, v108
    v_add_f32 v85, v85, v109
    v_add_f32 v86, v86, v110
    v_add_f32 v87, v87, v111
    v_add_f32 v88, v88, v112
    v_add_f32 v89, v89, v113
    v_add_f32 v90, v90, v114
    v_add_f32 v91, v91, v115
    v_add_f32 v92, v92, v116
    v_add_f32 v93, v93, v117
    v_add_f32 v94, v94, v118
    v_add_f32 v95, v95, v119
    v_cvt_pk_bf16_f32 v24, v80, v81
    v_cvt_pk_bf16_f32 v25, v82, v83
    v_cvt_pk_bf16_f32 v26, v84, v85
    v_cvt_pk_bf16_f32 v27, v86, v87
    v_cvt_pk_bf16_f32 v28, v88, v89
    v_cvt_pk_bf16_f32 v29, v90, v91
    v_cvt_pk_bf16_f32 v30, v92, v93
    v_cvt_pk_bf16_f32 v31, v94, v95
    v_and_b32 v30, v20, v30
    v_and_b32 v31, v20, v31
    s_mov_b32 s14, 2
    s_waitcnt vmcnt(4)
    s_branch L_P2
L_LONG:
    s_lshr_b32 s82, s70, 2
    s_lshl_b32 s82, s82, 7
    s_add_u32 s82, s82, 3072
    s_mul_i32 s88, s93, 28
    s_add_u32 s88, s88, s82
    s_mul_i32 s3, s75, 802816
    s_add_u32 s88, s88, s3
    s_lshl_b32 s3, s75, 6
    s_add_u32 s82, s82, s3
    s_mov_b64 s[64:65], s[44:45]
    s_mov_b32 s66, s46
    s_mov_b32 s87, 114688
    s_mov_b32 s3, 86016
    s_mov_b32 s86, s88
    s_cmp_eq_u32 s75, 0
    s_cselect_b32 s3, 57344, s3
    s_cselect_b32 s86, s88, s86
    v_mov_b32 v122, v7
    s_add_u32 m0, s93, s3
    s_waitcnt vmcnt(4)
    s_barrier
    ds_read_b64_tr_b16 v[64:65], v11 offset:0
    ds_read_b64_tr_b16 v[66:67], v11 offset:512
    ds_read_b64_tr_b16 v[68:69], v11 offset:2048
    ds_read_b64_tr_b16 v[70:71], v11 offset:2560
    ds_read_b64_tr_b16 v[72:73], v11 offset:4096
    ds_read_b64_tr_b16 v[74:75], v11 offset:4608
    v_fma_f32 v80, v104, v104, s79
    v_fma_f32 v81, v105, v105, s79
    v_fma_f32 v82, v106, v106, s79
    v_fma_f32 v83, v107, v107, s79
    v_fma_f32 v84, v108, v108, s79
    v_fma_f32 v85, v109, v109, s79
    v_fma_f32 v86, v110, v110, s79
    v_fma_f32 v87, v111, v111, s79
    v_fma_f32 v88, v112, v112, s79
    v_fma_f32 v89, v113, v113, s79
    v_fma_f32 v90, v114, v114, s79
    v_fma_f32 v91, v115, v115, s79
    v_fma_f32 v92, v116, v116, s79
    v_fma_f32 v93, v117, v117, s79
    v_fma_f32 v94, v118, v118, s79
    v_fma_f32 v95, v119, v119, s79
    v_mul_f32 v80, v80, v104
    v_mul_f32 v81, v81, v105
    v_mul_f32 v82, v82, v106
    v_mul_f32 v83, v83, v107
    v_mul_f32 v84, v84, v108
    v_mul_f32 v85, v85, v109
    v_mul_f32 v86, v86, v110
    v_mul_f32 v87, v87, v111
    v_mul_f32 v88, v88, v112
    v_mul_f32 v89, v89, v113
    v_mul_f32 v90, v90, v114
    v_mul_f32 v91, v91, v115
    v_mul_f32 v92, v92, v116
    v_mul_f32 v93, v93, v117
    v_mul_f32 v94, v94, v118
    v_mul_f32 v95, v95, v119
    v_exp_f32 v80, -v80
    s_setprio 1
    ds_read_b64_tr_b16 v[76:77], v11 offset:6144
    ds_read_b64_tr_b16 v[78:79], v11 offset:6656
    s_waitcnt lgkmcnt(6)
    v_mfma_f32_32x32x16_bf16 v[32:47], v[64:67], v[128:131], v[48:63]
    buffer_load_dwordx4 v122, s[64:67], s86 offen lds
    ds_read_b64_tr_b16 v[64:65], v11 offset:8192
    ds_read_b64_tr_b16 v[66:67], v11 offset:8704
    s_waitcnt lgkmcnt(6)
    v_mfma_f32_32x32x16_bf16 v[32:47], v[68:71], v[132:135], v[32:47]
    s_add_u32 m0, m0, 4096
    s_add_u32 s86, s86, s87
    ds_read_b64_tr_b16 v[68:69], v11 offset:10240
    ds_read_b64_tr_b16 v[70:71], v11 offset:10752
    s_waitcnt lgkmcnt(6)
    v_mfma_f32_32x32x16_bf16 v[32:47], v[72:75], v[136:139], v[32:47]
    buffer_load_dwordx4 v122, s[64:67], s86 offen lds
    ds_read_b64_tr_b16 v[72:73], v11 offset:12288
    ds_read_b64_tr_b16 v[74:75], v11 offset:12800
    s_waitcnt lgkmcnt(6)
    v_mfma_f32_32x32x16_bf16 v[32:47], v[76:79], v[140:143], v[32:47]
    s_add_u32 m0, m0, 4096
    s_add_u32 s86, s86, s87
    ds_read_b64_tr_b16 v[76:77], v11 offset:14336
    ds_read_b64_tr_b16 v[78:79], v11 offset:14848
    s_waitcnt lgkmcnt(6)
    v_mfma_f32_32x32x16_bf16 v[32:47], v[64:67], v[144:147], v[32:47]
    buffer_load_dwordx4 v122, s[64:67], s86 offen lds
    ds_read_b64_tr_b16 v[64:65], v11 offset:16384
    ds_read_b64_tr_b16 v[66:67], v11 offset:16896
    s_waitcnt lgkmcnt(6)
    v_mfma_f32_32x32x16_bf16 v[32:47], v[68:71], v[148:151], v[32:47]
    s_add_u32 m0, m0, 4096
    s_add_u32 s86, s86, s87
    ds_read_b64_tr_b16 v[68:69], v11 offset:18432
    ds_read_b64_tr_b16 v[70:71], v11 offset:18944
    s_waitcnt lgkmcnt(6)
    v_mfma_f32_32x32x16_bf16 v[32:47], v[72:75], v[152:155], v[32:47]
    buffer_load_dwordx4 v122, s[64:67], s86 offen lds
    s_setprio 0
    v_exp_f32 v81, -v81
    v_exp_f32 v82, -v82
    v_exp_f32 v83, -v83
    v_exp_f32 v84, -v84
    v_exp_f32 v85, -v85
    v_exp_f32 v86, -v86
    v_exp_f32 v87, -v87
    v_exp_f32 v88, -v88
    v_exp_f32 v89, -v89
    v_exp_f32 v90, -v90
    v_exp_f32 v91, -v91
    v_exp_f32 v92, -v92
    v_exp_f32 v93, -v93
    v_exp_f32 v94, -v94
    v_exp_f32 v95, -v95
    v_fma_f32 v80, v80, v14, v14
    v_fma_f32 v81, v81, v14, v14
    v_fma_f32 v82, v82, v14, v14
    v_fma_f32 v83, v83, v14, v14
    s_waitcnt vmcnt(4)
    v_mov_b32 v3, 163776
    v_mov_b32 v4, 1
    s_mov_b64 exec, 1
    ds_add_rtn_u32 v125, v3, v4
    s_mov_b64 exec, -1
    s_setprio 1
    ds_read_b64_tr_b16 v[72:73], v11 offset:20480
    ds_read_b64_tr_b16 v[74:75], v11 offset:20992
    s_waitcnt lgkmcnt(6)
    v_mfma_f32_32x32x16_bf16 v[32:47], v[76:79], v[156:159], v[32:47]
    s_add_u32 m0, m0, 4096
    s_add_u32 s86, s86, s87
    ds_read_b64_tr_b16 v[76:77], v11 offset:22528
    ds_read_b64_tr_b16 v[78:79], v11 offset:23040
    s_waitcnt lgkmcnt(6)
    v_mfma_f32_32x32x16_bf16 v[32:47], v[64:67], v[160:163], v[32:47]
    buffer_load_dwordx4 v122, s[64:67], s86 offen lds
    ds_read_b64_tr_b16 v[64:65], v11 offset:24576
    ds_read_b64_tr_b16 v[66:67], v11 offset:25088
    s_waitcnt lgkmcnt(6)
    v_mfma_f32_32x32x16_bf16 v[32:47], v[68:71], v[164:167], v[32:47]
    s_add_u32 m0, m0, 4096
    s_add_u32 s86, s86, s87
    ds_read_b64_tr_b16 v[68:69], v11 offset:26624
    ds_read_b64_tr_b16 v[70:71], v11 offset:27136
    s_waitcnt lgkmcnt(6)
    v_mfma_f32_32x32x16_bf16 v[32:47], v[72:75], v[168:171], v[32:47]
    buffer_load_dwordx4 v122, s[64:67], s86 offen lds
    ds_read_b64_tr_b16 v[72:73], v12 offset:0
    ds_read_b64_tr_b16 v[74:75], v12 offset:512
    s_waitcnt lgkmcnt(6)
    v_mfma_f32_32x32x16_bf16 v[32:47], v[76:79], v[172:175], v[32:47]
    s_add_u32 m0, m0, 4096
    s_add_u32 s86, s86, s87
    ds_read_b64_tr_b16 v[76:77], v12 offset:2048
    ds_read_b64_tr_b16 v[78:79], v12 offset:2560
    s_waitcnt lgkmcnt(6)
    v_mfma_f32_32x32x16_bf16 v[32:47], v[64:67], v[176:179], v[32:47]
    buffer_load_dwordx4 v122, s[64:67], s86 offen lds
    ds_read_b64_tr_b16 v[64:65], v12 offset:4096
    ds_read_b64_tr_b16 v[66:67], v12 offset:4608
    s_waitcnt lgkmcnt(6)
    v_mfma_f32_32x32x16_bf16 v[32:47], v[68:71], v[180:183], v[32:47]
    s_setprio 0
    v_fma_f32 v84, v84, v14, v14
    v_fma_f32 v85, v85, v14, v14
    v_fma_f32 v86, v86, v14, v14
    v_fma_f32 v87, v87, v14, v14
    v_fma_f32 v88, v88, v14, v14
    v_fma_f32 v89, v89, v14, v14
    v_fma_f32 v90, v90, v14, v14
    v_fma_f32 v91, v91, v14, v14
    v_fma_f32 v92, v92, v14, v14
    v_fma_f32 v93, v93, v14, v14
    v_fma_f32 v94, v94, v14, v14
    v_fma_f32 v95, v95, v14, v14
    v_rcp_f32 v80, v80
    v_rcp_f32 v81, v81
    v_rcp_f32 v82, v82
    v_rcp_f32 v83, v83
    v_rcp_f32 v84, v84
    v_rcp_f32 v85, v85
    v_rcp_f32 v86, v86
    v_rcp_f32 v87, v87
    v_rcp_f32 v88, v88
    v_rcp_f32 v89, v89
    v_rcp_f32 v90, v90
    s_setprio 1
    ds_read_b64_tr_b16 v[68:69], v12 offset:6144
    ds_read_b64_tr_b16 v[70:71], v12 offset:6656
    s_waitcnt lgkmcnt(6)
    v_mfma_f32_32x32x16_bf16 v[32:47], v[72:75], v[184:187], v[32:47]
    ds_read_b64_tr_b16 v[72:73], v12 offset:8192
    ds_read_b64_tr_b16 v[74:75], v12 offset:8704
    s_waitcnt lgkmcnt(6)
    v_mfma_f32_32x32x16_bf16 v[32:47], v[76:79], v[188:191], v[32:47]
    v_readfirstlane_b32 s3, v125
    s_nop 1
    s_cmp_lg_u32 s3, 7
    s_nop 6
    s_cbranch_scc1 L_SB25
    v_mov_b32 v4, 1
    s_mov_b64 exec, 1
    buffer_store_dword v4, v23, s[48:51], s11 offen offset:0 sc1
    s_mov_b64 exec, -1
L_SB25:
    ds_read_b64_tr_b16 v[76:77], v12 offset:10240
    ds_read_b64_tr_b16 v[78:79], v12 offset:10752
    s_waitcnt lgkmcnt(6)
    v_mfma_f32_32x32x16_bf16 v[32:47], v[64:67], v[192:195], v[32:47]
    ds_read_b64_tr_b16 v[64:65], v12 offset:12288
    ds_read_b64_tr_b16 v[66:67], v12 offset:12800
    s_waitcnt lgkmcnt(6)
    v_mfma_f32_32x32x16_bf16 v[32:47], v[68:71], v[196:199], v[32:47]
    ds_read_b64_tr_b16 v[68:69], v12 offset:14336
    ds_read_b64_tr_b16 v[70:71], v12 offset:14848
    s_waitcnt lgkmcnt(6)
    v_mfma_f32_32x32x16_bf16 v[32:47], v[72:75], v[200:203], v[32:47]
    ds_read_b64_tr_b16 v[72:73], v12 offset:16384
    ds_read_b64_tr_b16 v[74:75], v12 offset:16896
    s_waitcnt lgkmcnt(6)
    v_mfma_f32_32x32x16_bf16 v[32:47], v[76:79], v[204:207], v[32:47]
    ds_read_b64_tr_b16 v[76:77], v12 offset:18432
    ds_read_b64_tr_b16 v[78:79], v12 offset:18944
    s_waitcnt lgkmcnt(6)
    v_mfma_f32_32x32x16_bf16 v[32:47], v[64:67], v[208:211], v[32:47]
    s_setprio 0
    v_rcp_f32 v91, v91
    v_rcp_f32 v92, v92
    v_rcp_f32 v93, v93
    v_rcp_f32 v94, v94
    v_rcp_f32 v95, v95
    v_mul_f32 v80, v80, v104
    v_mul_f32 v81, v81, v105
    v_mul_f32 v82, v82, v106
    v_mul_f32 v83, v83, v107
    v_mul_f32 v84, v84, v108
    v_mul_f32 v85, v85, v109
    v_mul_f32 v86, v86, v110
    v_mul_f32 v87, v87, v111
    v_mul_f32 v88, v88, v112
    v_mul_f32 v89, v89, v113
    v_mul_f32 v90, v90, v114
    v_mul_f32 v91, v91, v115
    v_mul_f32 v92, v92, v116
    v_mul_f32 v93, v93, v117
    v_mul_f32 v94, v94, v118
    v_mul_f32 v95, v95, v119
    v_cvt_pk_bf16_f32 v96, v80, v81
    v_cvt_pk_bf16_f32 v97, v82, v83
    v_cvt_pk_bf16_f32 v98, v84, v85
    v_cvt_pk_bf16_f32 v99, v86, v87
    v_cvt_pk_bf16_f32 v100, v88, v89
    v_cvt_pk_bf16_f32 v101, v90, v91
    v_cvt_pk_bf16_f32 v102, v92, v93
    v_cvt_pk_bf16_f32 v103, v94, v95
    buffer_store_dwordx4 v[96:99], v13, s[48:51], s80 offen sc1
    buffer_store_dwordx4 v[100:103], v13, s[48:51], s80 offen offset:1024 sc1
    s_setprio 1
    ds_read_b64_tr_b16 v[64:65], v12 offset:20480
    ds_read_b64_tr_b16 v[66:67], v12 offset:20992
    s_waitcnt lgkmcnt(6)
    v_mfma_f32_32x32x16_bf16 v[32:47], v[68:71], v[212:215], v[32:47]
    ds_read_b64_tr_b16 v[68:69], v12 offset:22528
    ds_read_b64_tr_b16 v[70:71], v12 offset:23040
    s_waitcnt lgkmcnt(6)
    v_mfma_f32_32x32x16_bf16 v[32:47], v[72:75], v[216:219], v[32:47]
    ds_read_b64_tr_b16 v[72:73], v12 offset:24576
    ds_read_b64_tr_b16 v[74:75], v12 offset:25088
    s_waitcnt lgkmcnt(6)
    v_mfma_f32_32x32x16_bf16 v[32:47], v[76:79], v[220:223], v[32:47]
    ds_read_b64_tr_b16 v[76:77], v12 offset:26624
    ds_read_b64_tr_b16 v[78:79], v12 offset:27136
    s_waitcnt lgkmcnt(6)
    v_mfma_f32_32x32x16_bf16 v[32:47], v[64:67], v[224:227], v[32:47]
    s_waitcnt lgkmcnt(4)
    v_mfma_f32_32x32x16_bf16 v[32:47], v[68:71], v[228:231], v[32:47]
    s_lshl_b32 s3, s82, 1
    v_add_u32 v2, s3, v15
    ds_read_b128 v[48:51], v2 offset:0
    ds_read_b128 v[52:55], v2 offset:32
    ds_read_b128 v[56:59], v2 offset:64
    ds_read_b128 v[60:63], v2 offset:96
    v_add_u32 v11, 57344, v10
    v_add_u32 v12, 86016, v10
    s_lshl_b32 s3, s94, 5
    s_add_u32 s3, s3, 65536
    s_add_u32 s80, s3, s81
    s_add_u32 s88, s88, 256
    s_mov_b64 s[64:65], s[44:45]
    s_mov_b32 s66, s46
    s_mov_b32 s87, 114688
    s_mov_b32 s3, 0
    s_mov_b32 s86, s88
    s_cmp_eq_u32 s75, 0
    s_cselect_b32 s3, 114688, s3
    s_cselect_b32 s86, s88, s86
    v_mov_b32 v122, v7
    s_add_u32 m0, s93, s3
    s_waitcnt lgkmcnt(2)
    v_mfma_f32_32x32x16_bf16 v[32:47], v[72:75], v[232:235], v[32:47]
    s_waitcnt lgkmcnt(0)
    v_mfma_f32_32x32x16_bf16 v[104:119], v[76:79], v[236:239], v[32:47]
    s_setprio 0
    s_waitcnt vmcnt(2)
    s_barrier
    ds_read_b64_tr_b16 v[64:65], v11 offset:0
    ds_read_b64_tr_b16 v[66:67], v11 offset:512
    ds_read_b64_tr_b16 v[68:69], v11 offset:2048
    ds_read_b64_tr_b16 v[70:71], v11 offset:2560
    ds_read_b64_tr_b16 v[72:73], v11 offset:4096
    ds_read_b64_tr_b16 v[74:75], v11 offset:4608
    s_nop 2
    v_fma_f32 v80, v104, v104, s79
    v_fma_f32 v81, v105, v105, s79
    v_fma_f32 v82, v106, v106, s79
    v_fma_f32 v83, v107, v107, s79
    v_fma_f32 v84, v108, v108, s79
    v_fma_f32 v85, v109, v109, s79
    v_fma_f32 v86, v110, v110, s79
    v_fma_f32 v87, v111, v111, s79
    v_fma_f32 v88, v112, v112, s79
    v_fma_f32 v89, v113, v113, s79
    v_fma_f32 v90, v114, v114, s79
    v_fma_f32 v91, v115, v115, s79
    v_fma_f32 v92, v116, v116, s79
    v_fma_f32 v93, v117, v117, s79
    v_fma_f32 v94, v118, v118, s79
    v_fma_f32 v95, v119, v119, s79
    v_mul_f32 v80, v80, v104
    v_mul_f32 v81, v81, v105
    v_mul_f32 v82, v82, v106
    v_mul_f32 v83, v83, v107
    v_mul_f32 v84, v84, v108
    v_mul_f32 v85, v85, v109
    v_mul_f32 v86, v86, v110
    v_mul_f32 v87, v87, v111
    v_mul_f32 v88, v88, v112
    v_mul_f32 v89, v89, v113
    v_mul_f32 v90, v90, v114
    v_mul_f32 v91, v91, v115
    v_mul_f32 v92, v92, v116
    v_mul_f32 v93, v93, v117
    v_mul_f32 v94, v94, v118
    v_mul_f32 v95, v95, v119
    v_exp_f32 v80, -v80
    s_setprio 1
    ds_read_b64_tr_b16 v[76:77], v11 offset:6144
    ds_read_b64_tr_b16 v[78:79], v11 offset:6656
    s_waitcnt lgkmcnt(6)
    v_mfma_f32_32x32x16_bf16 v[32:47], v[64:67], v[128:131], v[48:63]
    buffer_load_dwordx4 v122, s[64:67], s86 offen lds
    ds_read_b64_tr_b16 v[64:65], v11 offset:8192
    ds_read_b64_tr_b16 v[66:67], v11 offset:8704
    s_waitcnt lgkmcnt(6)
    v_mfma_f32_32x32x16_bf16 v[32:47], v[68:71], v[132:135], v[32:47]
    s_add_u32 m0, m0, 4096
    s_add_u32 s86, s86, s87
    ds_read_b64_tr_b16 v[68:69], v11 offset:10240
    ds_read_b64_tr_b16 v[70:71], v11 offset:10752
    s_waitcnt lgkmcnt(6)
    v_mfma_f32_32x32x16_bf16 v[32:47], v[72:75], v[136:139], v[32:47]
    buffer_load_dwordx4 v122, s[64:67], s86 offen lds
    ds_read_b64_tr_b16 v[72:73], v11 offset:12288
    ds_read_b64_tr_b16 v[74:75], v11 offset:12800
    s_waitcnt lgkmcnt(6)
    v_mfma_f32_32x32x16_bf16 v[32:47], v[76:79], v[140:143], v[32:47]
    s_add_u32 m0, m0, 4096
    s_add_u32 s86, s86, s87
    ds_read_b64_tr_b16 v[76:77], v11 offset:14336
    ds_read_b64_tr_b16 v[78:79], v11 offset:14848
    s_waitcnt lgkmcnt(6)
    v_mfma_f32_32x32x16_bf16 v[32:47], v[64:67], v[144:147], v[32:47]
    buffer_load_dwordx4 v122, s[64:67], s86 offen lds
    ds_read_b64_tr_b16 v[64:65], v11 offset:16384
    ds_read_b64_tr_b16 v[66:67], v11 offset:16896
    s_waitcnt lgkmcnt(6)
    v_mfma_f32_32x32x16_bf16 v[32:47], v[68:71], v[148:151], v[32:47]
    s_add_u32 m0, m0, 4096
    s_add_u32 s86, s86, s87
    ds_read_b64_tr_b16 v[68:69], v11 offset:18432
    ds_read_b64_tr_b16 v[70:71], v11 offset:18944
    s_waitcnt lgkmcnt(6)
    v_mfma_f32_32x32x16_bf16 v[32:47], v[72:75], v[152:155], v[32:47]
    buffer_load_dwordx4 v122, s[64:67], s86 offen lds
    s_setprio 0
    v_exp_f32 v81, -v81
    v_exp_f32 v82, -v82
    v_exp_f32 v83, -v83
    v_exp_f32 v84, -v84
    v_exp_f32 v85, -v85
    v_exp_f32 v86, -v86
    v_exp_f32 v87, -v87
    v_exp_f32 v88, -v88
    v_exp_f32 v89, -v89
    v_exp_f32 v90, -v90
    v_exp_f32 v91, -v91
    v_exp_f32 v92, -v92
    v_exp_f32 v93, -v93
    v_exp_f32 v94, -v94
    v_exp_f32 v95, -v95
    v_fma_f32 v80, v80, v14, v14
    v_fma_f32 v81, v81, v14, v14
    v_fma_f32 v82, v82, v14, v14
    v_fma_f32 v83, v83, v14, v14
    s_waitcnt vmcnt(4)
    v_mov_b32 v3, 163780
    v_mov_b32 v4, 1
    s_mov_b64 exec, 1
    ds_add_rtn_u32 v125, v3, v4
    s_mov_b64 exec, -1
    s_setprio 1
    ds_read_b64_tr_b16 v[72:73], v11 offset:20480
    ds_read_b64_tr_b16 v[74:75], v11 offset:20992
    s_waitcnt lgkmcnt(6)
    v_mfma_f32_32x32x16_bf16 v[32:47], v[76:79], v[156:159], v[32:47]
    s_add_u32 m0, m0, 4096
    s_add_u32 s86, s86, s87
    ds_read_b64_tr_b16 v[76:77], v11 offset:22528
    ds_read_b64_tr_b16 v[78:79], v11 offset:23040
    s_waitcnt lgkmcnt(6)
    v_mfma_f32_32x32x16_bf16 v[32:47], v[64:67], v[160:163], v[32:47]
    buffer_load_dwordx4 v122, s[64:67], s86 offen lds
    ds_read_b64_tr_b16 v[64:65], v11 offset:24576
    ds_read_b64_tr_b16 v[66:67], v11 offset:25088
    s_waitcnt lgkmcnt(6)
    v_mfma_f32_32x32x16_bf16 v[32:47], v[68:71], v[164:167], v[32:47]
    s_add_u32 m0, m0, 4096
    s_add_u32 s86, s86, s87
    ds_read_b64_tr_b16 v[68:69], v11 offset:26624
    ds_read_b64_tr_b16 v[70:71], v11 offset:27136
    s_waitcnt lgkmcnt(6)
    v_mfma_f32_32x32x16_bf16 v[32:47], v[72:75], v[168:171], v[32:47]
    buffer_load_dwordx4 v122, s[64:67], s86 offen lds
    ds_read_b64_tr_b16 v[72:73], v12 offset:0
    ds_read_b64_tr_b16 v[74:75], v12 offset:512
    s_waitcnt lgkmcnt(6)
    v_mfma_f32_32x32x16_bf16 v[32:47], v[76:79], v[172:175], v[32:47]
    s_add_u32 m0, m0, 4096
    s_add_u32 s86, s86, s87
    ds_read_b64_tr_b16 v[76:77], v12 offset:2048
    ds_read_b64_tr_b16 v[78:79], v12 offset:2560
    s_waitcnt lgkmcnt(6)
    v_mfma_f32_32x32x16_bf16 v[32:47], v[64:67], v[176:179], v[32:47]
    buffer_load_dwordx4 v122, s[64:67], s86 offen lds
    ds_read_b64_tr_b16 v[64:65], v12 offset:4096
    ds_read_b64_tr_b16 v[66:67], v12 offset:4608
    s_waitcnt lgkmcnt(6)
    v_mfma_f32_32x32x16_bf16 v[32:47], v[68:71], v[180:183], v[32:47]
    s_setprio 0
    v_fma_f32 v84, v84, v14, v14
    v_fma_f32 v85, v85, v14, v14
    v_fma_f32 v86, v86, v14, v14
    v_fma_f32 v87, v87, v14, v14
    v_fma_f32 v88, v88, v14, v14
    v_fma_f32 v89, v89, v14, v14
    v_fma_f32 v90, v90, v14, v14
    v_fma_f32 v91, v91, v14, v14
    v_fma_f32 v92, v92, v14, v14
    v_fma_f32 v93, v93, v14, v14
    v_fma_f32 v94, v94, v14, v14
    v_fma_f32 v95, v95, v14, v14
    v_rcp_f32 v80, v80
    v_rcp_f32 v81, v81
    v_rcp_f32 v82, v82
    v_rcp_f32 v83, v83
    v_rcp_f32 v84, v84
    v_rcp_f32 v85, v85
    v_rcp_f32 v86, v86
    v_rcp_f32 v87, v87
    v_rcp_f32 v88, v88
    v_rcp_f32 v89, v89
    v_rcp_f32 v90, v90
    s_setprio 1
    ds_read_b64_tr_b16 v[68:69], v12 offset:6144
    ds_read_b64_tr_b16 v[70:71], v12 offset:6656
    s_waitcnt lgkmcnt(6)
    v_mfma_f32_32x32x16_bf16 v[32:47], v[72:75], v[184:187], v[32:47]
    ds_read_b64_tr_b16 v[72:73], v12 offset:8192
    ds_read_b64_tr_b16 v[74:75], v12 offset:8704
    s_waitcnt lgkmcnt(6)
    v_mfma_f32_32x32x16_bf16 v[32:47], v[76:79], v[188:191], v[32:47]
    v_readfirstlane_b32 s3, v125
    s_nop 1
    s_cmp_lg_u32 s3, 7
    s_nop 6
    s_cbranch_scc1 L_SB26
    v_mov_b32 v4, 1
    s_mov_b64 exec, 1
    buffer_store_dword v4, v23, s[48:51], s11 offen offset:128 sc1
    s_mov_b64 exec, -1
L_SB26:
    ds_read_b64_tr_b16 v[76:77], v12 offset:10240
    ds_read_b64_tr_b16 v[78:79], v12 offset:10752
    s_waitcnt lgkmcnt(6)
    v_mfma_f32_32x32x16_bf16 v[32:47], v[64:67], v[192:195], v[32:47]
    ds_read_b64_tr_b16 v[64:65], v12 offset:12288
    ds_read_b64_tr_b16 v[66:67], v12 offset:12800
    s_waitcnt lgkmcnt(6)
    v_mfma_f32_32x32x16_bf16 v[32:47], v[68:71], v[196:199], v[32:47]
    ds_read_b64_tr_b16 v[68:69], v12 offset:14336
    ds_read_b64_tr_b16 v[70:71], v12 offset:14848
    s_waitcnt lgkmcnt(6)
    v_mfma_f32_32x32x16_bf16 v[32:47], v[72:75], v[200:203], v[32:47]
    ds_read_b64_tr_b16 v[72:73], v12 offset:16384
    ds_read_b64_tr_b16 v[74:75], v12 offset:16896
    s_waitcnt lgkmcnt(6)
    v_mfma_f32_32x32x16_bf16 v[32:47], v[76:79], v[204:207], v[32:47]
    ds_read_b64_tr_b16 v[76:77], v12 offset:18432
    ds_read_b64_tr_b16 v[78:79], v12 offset:18944
    s_waitcnt lgkmcnt(6)
    v_mfma_f32_32x32x16_bf16 v[32:47], v[64:67], v[208:211], v[32:47]
    s_setprio 0
    v_rcp_f32 v91, v91
    v_rcp_f32 v92, v92
    v_rcp_f32 v93, v93
    v_rcp_f32 v94, v94
    v_rcp_f32 v95, v95
    v_mul_f32 v80, v80, v104
    v_mul_f32 v81, v81, v105
    v_mul_f32 v82, v82, v106
    v_mul_f32 v83, v83, v107
    v_mul_f32 v84, v84, v108
    v_mul_f32 v85, v85, v109
    v_mul_f32 v86, v86, v110
    v_mul_f32 v87, v87, v111
    v_mul_f32 v88, v88, v112
    v_mul_f32 v89, v89, v113
    v_mul_f32 v90, v90, v114
    v_mul_f32 v91, v91, v115
    v_mul_f32 v92, v92, v116
    v_mul_f32 v93, v93, v117
    v_mul_f32 v94, v94, v118
    v_mul_f32 v95, v95, v119
    v_cvt_pk_bf16_f32 v96, v80, v81
    v_cvt_pk_bf16_f32 v97, v82, v83
    v_cvt_pk_bf16_f32 v98, v84, v85
    v_cvt_pk_bf16_f32 v99, v86, v87
    v_cvt_pk_bf16_f32 v100, v88, v89
    v_cvt_pk_bf16_f32 v101, v90, v91
    v_cvt_pk_bf16_f32 v102, v92, v93
    v_cvt_pk_bf16_f32 v103, v94, v95
    buffer_store_dwordx4 v[96:99], v13, s[48:51], s80 offen sc1
    buffer_store_dwordx4 v[100:103], v13, s[48:51], s80 offen offset:1024 sc1
    s_setprio 1
    ds_read_b64_tr_b16 v[64:65], v12 offset:20480
    ds_read_b64_tr_b16 v[66:67], v12 offset:20992
    s_waitcnt lgkmcnt(6)
    v_mfma_f32_32x32x16_bf16 v[32:47], v[68:71], v[212:215], v[32:47]
    ds_read_b64_tr_b16 v[68:69], v12 offset:22528
    ds_read_b64_tr_b16 v[70:71], v12 offset:23040
    s_waitcnt lgkmcnt(6)
    v_mfma_f32_32x32x16_bf16 v[32:47], v[72:75], v[216:219], v[32:47]
    ds_read_b64_tr_b16 v[72:73], v12 offset:24576
    ds_read_b64_tr_b16 v[74:75], v12 offset:25088
    s_waitcnt lgkmcnt(6)
    v_mfma_f32_32x32x16_bf16 v[32:47], v[76:79], v[220:223], v[32:47]
    ds_read_b64_tr_b16 v[76:77], v12 offset:26624
    ds_read_b64_tr_b16 v[78:79], v12 offset:27136
    s_waitcnt lgkmcnt(6)
    v_mfma_f32_32x32x16_bf16 v[32:47], v[64:67], v[224:227], v[32:47]
    s_waitcnt lgkmcnt(4)
    v_mfma_f32_32x32x16_bf16 v[32:47], v[68:71], v[228:231], v[32:47]
    s_lshl_b32 s3, s82, 1
    v_add_u32 v2, s3, v15
    ds_read_b128 v[48:51], v2 offset:512
    ds_read_b128 v[52:55], v2 offset:544
    ds_read_b128 v[56:59], v2 offset:576
    ds_read_b128 v[60:63], v2 offset:608
    v_add_u32 v11, 114688, v10
    v_add_u32 v12, 0, v10
    s_lshl_b32 s3, s82, 5
    s_add_u32 s3, s3, 0
    s_add_u32 s80, s3, s81
    s_waitcnt lgkmcnt(2)
    v_mfma_f32_32x32x16_bf16 v[32:47], v[72:75], v[232:235], v[32:47]
    s_waitcnt lgkmcnt(0)
    v_mfma_f32_32x32x16_bf16 v[104:119], v[76:79], v[236:239], v[32:47]
    s_setprio 0
    s_waitcnt vmcnt(2)
    s_barrier
    ds_read_b64_tr_b16 v[64:65], v11 offset:0
    ds_read_b64_tr_b16 v[66:67], v11 offset:512
    ds_read_b64_tr_b16 v[68:69], v11 offset:2048
    ds_read_b64_tr_b16 v[70:71], v11 offset:2560
    ds_read_b64_tr_b16 v[72:73], v11 offset:4096
    ds_read_b64_tr_b16 v[74:75], v11 offset:4608
    s_nop 2
    v_fma_f32 v80, v104, v104, s79
    v_fma_f32 v81, v105, v105, s79
    v_fma_f32 v82, v106, v106, s79
    v_fma_f32 v83, v107, v107, s79
    v_fma_f32 v84, v108, v108, s79
    v_fma_f32 v85, v109, v109, s79
    v_fma_f32 v86, v110, v110, s79
    v_fma_f32 v87, v111, v111, s79
    v_fma_f32 v88, v112, v112, s79
    v_fma_f32 v89, v113, v113, s79
    v_fma_f32 v90, v114, v114, s79
    v_fma_f32 v91, v115, v115, s79
    v_fma_f32 v92, v116, v116, s79
    v_fma_f32 v93, v117, v117, s79
    v_fma_f32 v94, v118, v118, s79
    v_fma_f32 v95, v119, v119, s79
    v_mul_f32 v80, v80, v104
    v_mul_f32 v81, v81, v105
    v_mul_f32 v82, v82, v106
    v_mul_f32 v83, v83, v107
    v_mul_f32 v84, v84, v108
    v_mul_f32 v85, v85, v109
    v_mul_f32 v86, v86, v110
    v_mul_f32 v87, v87, v111
    v_mul_f32 v88, v88, v112
    v_mul_f32 v89, v89, v113
    v_mul_f32 v90, v90, v114
    v_mul_f32 v91, v91, v115
    v_mul_f32 v92, v92, v116
    v_mul_f32 v93, v93, v117
    v_mul_f32 v94, v94, v118
    v_mul_f32 v95, v95, v119
    v_exp_f32 v80, -v80
    s_setprio 1
    ds_read_b64_tr_b16 v[76:77], v11 offset:6144
    ds_read_b64_tr_b16 v[78:79], v11 offset:6656
    s_waitcnt lgkmcnt(6)
    v_mfma_f32_32x32x16_bf16 v[32:47], v[64:67], v[128:131], v[48:63]
    ds_read_b64_tr_b16 v[64:65], v11 offset:8192
    ds_read_b64_tr_b16 v[66:67], v11 offset:8704
    s_waitcnt lgkmcnt(6)
    v_mfma_f32_32x32x16_bf16 v[32:47], v[68:71], v[132:135], v[32:47]
    ds_read_b64_tr_b16 v[68:69], v11 offset:10240
    ds_read_b64_tr_b16 v[70:71], v11 offset:10752
    s_waitcnt lgkmcnt(6)
    v_mfma_f32_32x32x16_bf16 v[32:47], v[72:75], v[136:139], v[32:47]
    ds_read_b64_tr_b16 v[72:73], v11 offset:12288
    ds_read_b64_tr_b16 v[74:75], v11 offset:12800
    s_waitcnt lgkmcnt(6)
    v_mfma_f32_32x32x16_bf16 v[32:47], v[76:79], v[140:143], v[32:47]
    ds_read_b64_tr_b16 v[76:77], v11 offset:14336
    ds_read_b64_tr_b16 v[78:79], v11 offset:14848
    s_waitcnt lgkmcnt(6)
    v_mfma_f32_32x32x16_bf16 v[32:47], v[64:67], v[144:147], v[32:47]
    ds_read_b64_tr_b16 v[64:65], v11 offset:16384
    ds_read_b64_tr_b16 v[66:67], v11 offset:16896
    s_waitcnt lgkmcnt(6)
    v_mfma_f32_32x32x16_bf16 v[32:47], v[68:71], v[148:151], v[32:47]
    ds_read_b64_tr_b16 v[68:69], v11 offset:18432
    ds_read_b64_tr_b16 v[70:71], v11 offset:18944
    s_waitcnt lgkmcnt(6)
    v_mfma_f32_32x32x16_bf16 v[32:47], v[72:75], v[152:155], v[32:47]
    s_setprio 0
    v_exp_f32 v81, -v81
    v_exp_f32 v82, -v82
    v_exp_f32 v83, -v83
    v_exp_f32 v84, -v84
    v_exp_f32 v85, -v85
    v_exp_f32 v86, -v86
    v_exp_f32 v87, -v87
    v_exp_f32 v88, -v88
    v_exp_f32 v89, -v89
    v_exp_f32 v90, -v90
    v_exp_f32 v91, -v91
    v_exp_f32 v92, -v92
    v_exp_f32 v93, -v93
    v_exp_f32 v94, -v94
    v_exp_f32 v95, -v95
    v_fma_f32 v80, v80, v14, v14
    v_fma_f32 v81, v81, v14, v14
    v_fma_f32 v82, v82, v14, v14
    v_fma_f32 v83, v83, v14, v14
    s_waitcnt vmcnt(0)
    v_mov_b32 v3, 163784
    v_mov_b32 v4, 1
    s_mov_b64 exec, 1
    ds_add_rtn_u32 v125, v3, v4
    s_mov_b64 exec, -1
    s_setprio 1
    ds_read_b64_tr_b16 v[72:73], v11 offset:20480
    ds_read_b64_tr_b16 v[74:75], v11 offset:20992
    s_waitcnt lgkmcnt(6)
    v_mfma_f32_32x32x16_bf16 v[32:47], v[76:79], v[156:159], v[32:47]
    ds_read_b64_tr_b16 v[76:77], v11 offset:22528
    ds_read_b64_tr_b16 v[78:79], v11 offset:23040
    s_waitcnt lgkmcnt(6)
    v_mfma_f32_32x32x16_bf16 v[32:47], v[64:67], v[160:163], v[32:47]
    ds_read_b64_tr_b16 v[64:65], v11 offset:24576
    ds_read_b64_tr_b16 v[66:67], v11 offset:25088
    s_waitcnt lgkmcnt(6)
    v_mfma_f32_32x32x16_bf16 v[32:47], v[68:71], v[164:167], v[32:47]
    ds_read_b64_tr_b16 v[68:69], v11 offset:26624
    ds_read_b64_tr_b16 v[70:71], v11 offset:27136
    s_waitcnt lgkmcnt(6)
    v_mfma_f32_32x32x16_bf16 v[32:47], v[72:75], v[168:171], v[32:47]
    v_readfirstlane_b32 s3, v125
    s_nop 1
    s_cmp_lg_u32 s3, 7
    s_nop 6
    s_cbranch_scc1 L_SB27
    v_mov_b32 v4, 1
    s_mov_b64 exec, 1
    buffer_store_dword v4, v23, s[48:51], s11 offen offset:256 sc1
    s_mov_b64 exec, -1
L_SB27:
    ds_read_b64_tr_b16 v[72:73], v12 offset:0
    ds_read_b64_tr_b16 v[74:75], v12 offset:512
    s_waitcnt lgkmcnt(6)
    v_mfma_f32_32x32x16_bf16 v[32:47], v[76:79], v[172:175], v[32:47]
    ds_read_b64_tr_b16 v[76:77], v12 offset:2048
    ds_read_b64_tr_b16 v[78:79], v12 offset:2560
    s_waitcnt lgkmcnt(6)
    v_mfma_f32_32x32x16_bf16 v[32:47], v[64:67], v[176:179], v[32:47]
    ds_read_b64_tr_b16 v[64:65], v12 offset:4096
    ds_read_b64_tr_b16 v[66:67], v12 offset:4608
    s_waitcnt lgkmcnt(6)
    v_mfma_f32_32x32x16_bf16 v[32:47], v[68:71], v[180:183], v[32:47]
    s_setprio 0
    v_fma_f32 v84, v84, v14, v14
    v_fma_f32 v85, v85, v14, v14
    v_fma_f32 v86, v86, v14, v14
    v_fma_f32 v87, v87, v14, v14
    v_fma_f32 v88, v88, v14, v14
    v_fma_f32 v89, v89, v14, v14
    v_fma_f32 v90, v90, v14, v14
    v_fma_f32 v91, v91, v14, v14
    v_fma_f32 v92, v92, v14, v14
    v_fma_f32 v93, v93, v14, v14
    v_fma_f32 v94, v94, v14, v14
    v_fma_f32 v95, v95, v14, v14
    v_rcp_f32 v80, v80
    v_rcp_f32 v81, v81
    v_rcp_f32 v82, v82
    v_rcp_f32 v83, v83
    v_rcp_f32 v84, v84
    v_rcp_f32 v85, v85
    v_rcp_f32 v86, v86
    v_rcp_f32 v87, v87
    v_rcp_f32 v88, v88
    v_rcp_f32 v89, v89
    v_rcp_f32 v90, v90
    s_setprio 1
    ds_read_b64_tr_b16 v[68:69], v12 offset:6144
    ds_read_b64_tr_b16 v[70:71], v12 offset:6656
    s_waitcnt lgkmcnt(6)
    v_mfma_f32_32x32x16_bf16 v[32:47], v[72:75], v[184:187], v[32:47]
    ds_read_b64_tr_b16 v[72:73], v12 offset:8192
    ds_read_b64_tr_b16 v[74:75], v12 offset:8704
    s_waitcnt lgkmcnt(6)
    v_mfma_f32_32x32x16_bf16 v[32:47], v[76:79], v[188:191], v[32:47]
    ds_read_b64_tr_b16 v[76:77], v12 offset:10240
    ds_read_b64_tr_b16 v[78:79], v12 offset:10752
    s_waitcnt lgkmcnt(6)
    v_mfma_f32_32x32x16_bf16 v[32:47], v[64:67], v[192:195], v[32:47]
    ds_read_b64_tr_b16 v[64:65], v12 offset:12288
    ds_read_b64_tr_b16 v[66:67], v12 offset:12800
    s_waitcnt lgkmcnt(6)
    v_mfma_f32_32x32x16_bf16 v[32:47], v[68:71], v[196:199], v[32:47]
    ds_read_b64_tr_b16 v[68:69], v12 offset:14336
    ds_read_b64_tr_b16 v[70:71], v12 offset:14848
    s_waitcnt lgkmcnt(6)
    v_mfma_f32_32x32x16_bf16 v[32:47], v[72:75], v[200:203], v[32:47]
    ds_read_b64_tr_b16 v[72:73], v12 offset:16384
    ds_read_b64_tr_b16 v[74:75], v12 offset:16896
    s_waitcnt lgkmcnt(6)
    v_mfma_f32_32x32x16_bf16 v[32:47], v[76:79], v[204:207], v[32:47]
    ds_read_b64_tr_b16 v[76:77], v12 offset:18432
    ds_read_b64_tr_b16 v[78:79], v12 offset:18944
    s_waitcnt lgkmcnt(6)
    v_mfma_f32_32x32x16_bf16 v[32:47], v[64:67], v[208:211], v[32:47]
    s_setprio 0
    v_rcp_f32 v91, v91
    v_rcp_f32 v92, v92
    v_rcp_f32 v93, v93
    v_rcp_f32 v94, v94
    v_rcp_f32 v95, v95
    v_mul_f32 v80, v80, v104
    v_mul_f32 v81, v81, v105
    v_mul_f32 v82, v82, v106
    v_mul_f32 v83, v83, v107
    v_mul_f32 v84, v84, v108
    v_mul_f32 v85, v85, v109
    v_mul_f32 v86, v86, v110
    v_mul_f32 v87, v87, v111
    v_mul_f32 v88, v88, v112
    v_mul_f32 v89, v89, v113
    v_mul_f32 v90, v90, v114
    v_mul_f32 v91, v91, v115
    v_mul_f32 v92, v92, v116
    v_mul_f32 v93, v93, v117
    v_mul_f32 v94, v94, v118
    v_mul_f32 v95, v95, v119
    v_cvt_pk_bf16_f32 v96, v80, v81
    v_cvt_pk_bf16_f32 v97, v82, v83
    v_cvt_pk_bf16_f32 v98, v84, v85
    v_cvt_pk_bf16_f32 v99, v86, v87
    v_cvt_pk_bf16_f32 v100, v88, v89
    v_cvt_pk_bf16_f32 v101, v90, v91
    v_cvt_pk_bf16_f32 v102, v92, v93
    v_cvt_pk_bf16_f32 v103, v94, v95
    buffer_store_dwordx4 v[96:99], v13, s[48:51], s80 offen sc1
    buffer_store_dwordx4 v[100:103], v13, s[48:51], s80 offen offset:1024 sc1
    s_setprio 1
    ds_read_b64_tr_b16 v[64:65], v12 offset:20480
    ds_read_b64_tr_b16 v[66:67], v12 offset:20992
    s_waitcnt lgkmcnt(6)
    v_mfma_f32_32x32x16_bf16 v[32:47], v[68:71], v[212:215], v[32:47]
    ds_read_b64_tr_b16 v[68:69], v12 offset:22528
    ds_read_b64_tr_b16 v[70:71], v12 offset:23040
    s_waitcnt lgkmcnt(6)
    v_mfma_f32_32x32x16_bf16 v[32:47], v[72:75], v[216:219], v[32:47]
    ds_read_b64_tr_b16 v[72:73], v12 offset:24576
    ds_read_b64_tr_b16 v[74:75], v12 offset:25088
    s_waitcnt lgkmcnt(6)
    v_mfma_f32_32x32x16_bf16 v[32:47], v[76:79], v[220:223], v[32:47]
    ds_read_b64_tr_b16 v[76:77], v12 offset:26624
    ds_read_b64_tr_b16 v[78:79], v12 offset:27136
    s_waitcnt lgkmcnt(6)
    v_mfma_f32_32x32x16_bf16 v[32:47], v[64:67], v[224:227], v[32:47]
    s_waitcnt lgkmcnt(4)
    v_mfma_f32_32x32x16_bf16 v[32:47], v[68:71], v[228:231], v[32:47]
    s_lshl_b32 s3, s82, 5
    s_add_u32 s3, s3, 8192
    s_add_u32 s80, s3, s81
    s_waitcnt lgkmcnt(2)
    v_mfma_f32_32x32x16_bf16 v[32:47], v[72:75], v[232:235], v[32:47]
    s_waitcnt lgkmcnt(0)
    v_mfma_f32_32x32x16_bf16 v[104:119], v[76:79], v[236:239], v[32:47]
    s_setprio 0
    s_nop 10
    v_fma_f32 v80, v104, v104, s79
    v_fma_f32 v81, v105, v105, s79
    v_fma_f32 v82, v106, v106, s79
    v_fma_f32 v83, v107, v107, s79
    v_fma_f32 v84, v108, v108, s79
    v_fma_f32 v85, v109, v109, s79
    v_fma_f32 v86, v110, v110, s79
    v_fma_f32 v87, v111, v111, s79
    v_fma_f32 v88, v112, v112, s79
    v_fma_f32 v89, v113, v113, s79
    v_fma_f32 v90, v114, v114, s79
    v_fma_f32 v91, v115, v115, s79
    v_fma_f32 v92, v116, v116, s79
    v_fma_f32 v93, v117, v117, s79
    v_fma_f32 v94, v118, v118, s79
    v_fma_f32 v95, v119, v119, s79
    v_mul_f32 v80, v80, v104
    v_mul_f32 v81, v81, v105
    v_mul_f32 v82, v82, v106
    v_mul_f32 v83, v83, v107
    v_mul_f32 v84, v84, v108
    v_mul_f32 v85, v85, v109
    v_mul_f32 v86, v86, v110
    v_mul_f32 v87, v87, v111
    v_mul_f32 v88, v88, v112
    v_mul_f32 v89, v89, v113
    v_mul_f32 v90, v90, v114
    v_mul_f32 v91, v91, v115
    v_mul_f32 v92, v92, v116
    v_mul_f32 v93, v93, v117
    v_mul_f32 v94, v94, v118
    v_mul_f32 v95, v95, v119
    v_exp_f32 v80, -v80
    v_exp_f32 v81, -v81
    v_exp_f32 v82, -v82
    v_exp_f32 v83, -v83
    v_exp_f32 v84, -v84
    v_exp_f32 v85, -v85
    v_exp_f32 v86, -v86
    v_exp_f32 v87, -v87
    v_exp_f32 v88, -v88
    v_exp_f32 v89, -v89
    v_exp_f32 v90, -v90
    v_exp_f32 v91, -v91
    v_exp_f32 v92, -v92
    v_exp_f32 v93, -v93
    v_exp_f32 v94, -v94
    v_exp_f32 v95, -v95
    v_fma_f32 v80, v80, v14, v14
    v_fma_f32 v81, v81, v14, v14
    v_fma_f32 v82, v82, v14, v14
    v_fma_f32 v83, v83, v14, v14
    v_fma_f32 v84, v84, v14, v14
    v_fma_f32 v85, v85, v14, v14
    v_fma_f32 v86, v86, v14, v14
    v_fma_f32 v87, v87, v14, v14
    v_fma_f32 v88, v88, v14, v14
    v_fma_f32 v89, v89, v14, v14
    v_fma_f32 v90, v90, v14, v14
    v_fma_f32 v91, v91, v14, v14
    v_fma_f32 v92, v92, v14, v14
    v_fma_f32 v93, v93, v14, v14
    v_fma_f32 v94, v94, v14, v14
    v_fma_f32 v95, v95, v14, v14
    v_rcp_f32 v80, v80
    v_rcp_f32 v81, v81
    v_rcp_f32 v82, v82
    v_rcp_f32 v83, v83
    v_rcp_f32 v84, v84
    v_rcp_f32 v85, v85
    v_rcp_f32 v86, v86
    v_rcp_f32 v87, v87
    v_rcp_f32 v88, v88
    v_rcp_f32 v89, v89
    v_rcp_f32 v90, v90
    v_rcp_f32 v91, v91
    v_rcp_f32 v92, v92
    v_rcp_f32 v93, v93
    v_rcp_f32 v94, v94
    v_rcp_f32 v95, v95
    v_mul_f32 v80, v80, v104
    v_mul_f32 v81, v81, v105
    v_mul_f32 v82, v82, v106
    v_mul_f32 v83, v83, v107
    v_mul_f32 v84, v84, v108
    v_mul_f32 v85, v85, v109
    v_mul_f32 v86, v86, v110
    v_mul_f32 v87, v87, v111
    v_mul_f32 v88, v88, v112
    v_mul_f32 v89, v89, v113
    v_mul_f32 v90, v90, v114
    v_mul_f32 v91, v91, v115
    v_mul_f32 v92, v92, v116
    v_mul_f32 v93, v93, v117
    v_mul_f32 v94, v94, v118
    v_mul_f32 v95, v95, v119
    v_cvt_pk_bf16_f32 v96, v80, v81
    v_cvt_pk_bf16_f32 v97, v82, v83
    v_cvt_pk_bf16_f32 v98, v84, v85
    v_cvt_pk_bf16_f32 v99, v86, v87
    v_cvt_pk_bf16_f32 v100, v88, v89
    v_cvt_pk_bf16_f32 v101, v90, v91
    v_cvt_pk_bf16_f32 v102, v92, v93
    v_cvt_pk_bf16_f32 v103, v94, v95
    buffer_store_dwordx4 v[96:99], v13, s[48:51], s80 offen sc1
    buffer_store_dwordx4 v[100:103], v13, s[48:51], s80 offen offset:1024 sc1
    s_waitcnt vmcnt(2)
    v_mov_b32 v3, 163792
    v_mov_b32 v4, 1
    s_mov_b64 exec, 1
    ds_add_rtn_u32 v5, v3, v4
    s_mov_b64 exec, -1
    s_waitcnt lgkmcnt(0)
    v_readfirstlane_b32 s3, v5
    s_nop 1
    s_cmp_lg_u32 s3, 7
    s_nop 0
    s_cbranch_scc1 L_SG28
    v_mov_b32 v4, 1
    s_mov_b64 exec, 1
    buffer_store_dword v4, v23, s[48:51], s11 offen offset:384 sc1
    s_mov_b64 exec, -1
L_SG28:
    s_waitcnt vmcnt(0)
    v_mov_b32 v3, 163796
    v_mov_b32 v4, 1
    s_mov_b64 exec, 1
    ds_add_rtn_u32 v5, v3, v4
    s_mov_b64 exec, -1
    s_waitcnt lgkmcnt(0)
    v_readfirstlane_b32 s3, v5
    s_nop 1
    s_cmp_lg_u32 s3, 7
    s_nop 0
    s_cbranch_scc1 L_SG29
    s_sub_u32 s11, s11, 4096
    v_mov_b32 v4, 1
    s_mov_b64 exec, 1
    buffer_store_dword v4, v23, s[48:51], s11 offen offset:384 sc1
    s_mov_b64 exec, -1
L_SG29:
    s_branch L_END
L_P2:
    s_cmp_eq_u32 s75, 0
    s_cselect_b64 s[44:45], s[56:57], s[60:61]
    s_cselect_b32 s46, s58, s62
    s_add_u32 m0, s22, 0
    s_add_u32 s3, s98, 802816
    buffer_load_dwordx4 v6, s[56:59], s3 offen lds
    s_add_u32 m0, s22, 1024
    s_add_u32 s3, s98, 809984
    buffer_load_dwordx4 v6, s[56:59], s3 offen lds
    v_add_u32 v11, 28672, v18
    v_xor_b32 v12, 64, v11
    ds_read_b64_tr_b16 v[88:89], v11
    ds_read_b64_tr_b16 v[90:91], v11 offset:1024
    ds_read_b64_tr_b16 v[92:93], v12
    ds_read_b64_tr_b16 v[94:95], v12 offset:1024
    v_add_u32 v11, 45056, v18
    v_xor_b32 v12, 64, v11
    ds_read_b64_tr_b16 v[96:97], v11
    ds_read_b64_tr_b16 v[98:99], v11 offset:1024
    ds_read_b64_tr_b16 v[100:101], v12
    ds_read_b64_tr_b16 v[102:103], v12 offset:1024
    v_add_u32 v11, 61440, v18
    v_xor_b32 v12, 64, v11
    ds_read_b64_tr_b16 v[104:105], v11
    ds_read_b64_tr_b16 v[106:107], v11 offset:1024
    ds_read_b64_tr_b16 v[108:109], v12
    ds_read_b64_tr_b16 v[110:111], v12 offset:1024
    v_add_u32 v11, 77824, v18
    v_xor_b32 v12, 64, v11
    s_waitcnt lgkmcnt(8)
    ds_read_b64_tr_b16 v[112:113], v11
    ds_read_b64_tr_b16 v[114:115], v11 offset:1024
    ds_read_b64_tr_b16 v[116:117], v12
    ds_read_b64_tr_b16 v[118:119], v12 offset:1024
    v_add_u32 v11, 94208, v18
    v_xor_b32 v12, 64, v11
    s_waitcnt lgkmcnt(8)
    ds_read_b64_tr_b16 v[120:121], v11
    ds_read_b64_tr_b16 v[122:123], v11 offset:1024
    ds_read_b64_tr_b16 v[124:125], v12
    ds_read_b64_tr_b16 v[126:127], v12 offset:1024
    s_waitcnt vmcnt(2)
    v_add_u32 v11, 114688, v18
    v_xor_b32 v12, 64, v11
    s_waitcnt lgkmcnt(8)
    ds_read_b64_tr_b16 v[224:225], v11
    ds_read_b64_tr_b16 v[226:227], v11 offset:1024
    ds_read_b64_tr_b16 v[228:229], v12
    ds_read_b64_tr_b16 v[230:231], v12 offset:1024
    s_add_u32 m0, s22, 28672
    s_add_u32 s3, s98, 917504
    buffer_load_dwordx4 v6, s[56:59], s3 offen lds
    s_add_u32 m0, s22, 29696
    s_add_u32 s3, s98, 924672
    buffer_load_dwordx4 v6, s[56:59], s3 offen lds
    v_add_u32 v11, 131072, v18
    v_xor_b32 v12, 64, v11
    s_waitcnt lgkmcnt(8)
    ds_read_b64_tr_b16 v[232:233], v11
    ds_read_b64_tr_b16 v[234:235], v11 offset:1024
    ds_read_b64_tr_b16 v[236:237], v12
    ds_read_b64_tr_b16 v[238:239], v12 offset:1024
    s_add_u32 m0, s22, 45056
    s_add_u32 s3, s98, 1032192
    buffer_load_dwordx4 v6, s[56:59], s3 offen lds
    s_add_u32 m0, s22, 46080
    s_add_u32 s3, s98, 1039360
    buffer_load_dwordx4 v6, s[56:59], s3 offen lds
    s_cmp_eq_u32 s14, 0
    s_cbranch_scc0 L_O30
    v_mov_b32 v3, 163784
    v_mov_b32 v4, 1
    s_mov_b64 exec, 1
    ds_add_rtn_u32 v5, v3, v4
    s_mov_b64 exec, -1
    s_waitcnt lgkmcnt(0)
    v_readfirstlane_b32 s3, v5
    s_nop 1
    s_cmp_lg_u32 s3, 7
    s_nop 0
    s_cbranch_scc1 L_SG31
    v_mov_b32 v4, 1
    s_mov_b64 exec, 1
    buffer_store_dword v4, v23, s[48:51], s11 offen offset:256 sc1
    s_mov_b64 exec, -1
L_SG31:
L_O30:
    s_setprio 2
    s_add_u32 m0, s22, 61440
    s_add_u32 s3, s98, 1146880
    buffer_load_dwordx4 v6, s[56:59], s3 offen lds
    s_add_u32 m0, s22, 62464
    s_add_u32 s3, s98, 1154048
    buffer_load_dwordx4 v6, s[56:59], s3 offen lds
    s_waitcnt vmcnt(6)
    v_add_u32 v11, 0, v18
    v_xor_b32 v12, 64, v11
    s_waitcnt lgkmcnt(8)
    ds_read_b64_tr_b16 v[240:241], v11
    ds_read_b64_tr_b16 v[242:243], v11 offset:1024
    ds_read_b64_tr_b16 v[244:245], v12
    ds_read_b64_tr_b16 v[246:247], v12 offset:1024
    s_add_u32 m0, s22, 77824
    s_add_u32 s3, s98, 1261568
    buffer_load_dwordx4 v6, s[56:59], s3 offen lds
    s_add_u32 m0, s22, 78848
    s_add_u32 s3, s98, 1268736
    buffer_load_dwordx4 v6, s[56:59], s3 offen lds
    s_cmp_eq_u32 s14, 2
    s_cbranch_scc0 L_O32
    s_cmp_lg_u32 s68, 0
    s_cbranch_scc1 L_PI33
    v_lshlrev_b32 v2, 13, v1
    s_mov_b64 exec, 65535
    buffer_load_dword v17, v2, s[48:51], s12 offen sc1
    s_mov_b64 exec, -1
L_PI33:
L_O32:
    s_add_u32 m0, s22, 94208
    s_add_u32 s3, s89, 0
    buffer_load_dwordx4 v6, s[60:63], s3 offen lds
    s_add_u32 m0, s22, 95232
    s_add_u32 s3, s89, 7168
    buffer_load_dwordx4 v6, s[60:63], s3 offen lds
    s_waitcnt lgkmcnt(8)
    s_add_u32 m0, s22, 114688
    s_add_u32 s3, s89, 100352
    buffer_load_dwordx4 v6, s[60:63], s3 offen lds
    s_add_u32 m0, s22, 115712
    s_add_u32 s3, s89, 107520
    buffer_load_dwordx4 v6, s[60:63], s3 offen lds
    s_cmp_eq_u32 s14, 2
    s_cbranch_scc0 L_O34
    s_setprio 3
    s_waitcnt vmcnt(4)
    s_call_b64 s[96:97], OST_LOAD
    s_setprio 2
L_O34:
    v_mov_b32 v3, 163808
    s_cmp_lg_u32 s68, 0
    s_cbranch_scc1 L_PO35
    s_mov_b32 s85, 0
L_PC37:
    v_cmp_eq_u32 vcc, 1, v248
    s_nop 1
    s_and_b32 s3, vcc_lo, 65280
    s_cmp_eq_u32 s3, 65280
    s_cbranch_scc1 L_PD38
    s_add_u32 s85, s85, 1
    s_cmp_gt_u32 s85, 200000
    s_cbranch_scc1 L_PD38
    s_sleep 4
    s_mov_b64 exec, 65280
    buffer_load_dword v248, v19, s[48:51], s13 offen offset:0 sc1
    s_mov_b64 exec, -1
    s_waitcnt vmcnt(0)
    s_branch L_PC37
L_PD38:
    v_mov_b32 v4, 1
    ds_write_b32 v3, v4
    s_waitcnt lgkmcnt(0)
    s_branch L_PJ36
L_PO35:
    s_mov_b32 s85, 0
L_PO35_l:
    ds_read_b32 v4, v3
    s_waitcnt lgkmcnt(0)
    v_readfirstlane_b32 s3, v4
    s_nop 1
    s_cmp_lg_u32 s3, 0
    s_nop 0
    s_cbranch_scc1 L_PJ36
    s_add_u32 s85, s85, 1
    s_cmp_gt_u32 s85, 3200000
    s_cbranch_scc1 L_PJ36
    s_sleep 1
    s_branch L_PO35_l
L_PJ36:
    s_cmp_lg_u32 s68, 0
    s_cbranch_scc1 L_PI39
    s_mov_b64 exec, 65280
    buffer_load_dword v249, v19, s[48:51], s13 offen offset:128 sc1
    s_mov_b64 exec, -1
L_PI39:
    s_add_u32 s3, s95, 0
    buffer_load_dwordx4 v[128:131], v13, s[48:51], s3 offen sc1
    s_add_u32 s3, s95, 0
    buffer_load_dwordx4 v[132:135], v9, s[48:51], s3 offen sc1
    s_add_u32 s3, s95, 8192
    buffer_load_dwordx4 v[136:139], v13, s[48:51], s3 offen sc1
    s_add_u32 s3, s95, 8192
    buffer_load_dwordx4 v[140:143], v9, s[48:51], s3 offen sc1
    s_add_u32 m0, s22, 131072
    s_add_u32 s3, s100, 0
    buffer_load_dwordx4 v6, s[44:47], s3 offen lds
    s_add_u32 m0, s22, 132096
    s_add_u32 s3, s100, 7168
    buffer_load_dwordx4 v6, s[44:47], s3 offen lds
    s_add_u32 s100, s100, s101
    s_cmp_eq_u32 s14, 2
    s_cbranch_scc0 L_O40
    s_setprio 3
    s_waitcnt vmcnt(6)
    s_call_b64 s[96:97], OST_COMP
    s_setprio 2
L_O40:
    s_add_u32 s3, s95, 16384
    buffer_load_dwordx4 v[144:147], v13, s[48:51], s3 offen sc1
    s_add_u32 s3, s95, 16384
    buffer_load_dwordx4 v[148:151], v9, s[48:51], s3 offen sc1
    s_waitcnt vmcnt(6)
    v_mfma_f32_32x32x16_bf16 v[24:39], v[88:91], v[128:131], 0
    v_mfma_f32_32x32x16_bf16 v[40:55], v[92:95], v[128:131], 0
    v_mfma_f32_32x32x16_bf16 v[56:71], v[88:91], v[132:135], 0
    v_mfma_f32_32x32x16_bf16 v[72:87], v[92:95], v[132:135], 0
    v_add_u32 v11, 28672, v18
    v_xor_b32 v12, 64, v11
    ds_read_b64_tr_b16 v[88:89], v11
    ds_read_b64_tr_b16 v[90:91], v11 offset:1024
    ds_read_b64_tr_b16 v[92:93], v12
    ds_read_b64_tr_b16 v[94:95], v12 offset:1024
    s_add_u32 s3, s95, 24576
    buffer_load_dwordx4 v[152:155], v13, s[48:51], s3 offen sc1
    s_add_u32 s3, s95, 24576
    buffer_load_dwordx4 v[156:159], v9, s[48:51], s3 offen sc1
    s_waitcnt vmcnt(6)
    v_mfma_f32_32x32x16_bf16 v[24:39], v[96:99], v[136:139], v[24:39]
    v_mfma_f32_32x32x16_bf16 v[40:55], v[100:103], v[136:139], v[40:55]
    v_mfma_f32_32x32x16_bf16 v[56:71], v[96:99], v[140:143], v[56:71]
    v_mfma_f32_32x32x16_bf16 v[72:87], v[100:103], v[140:143], v[72:87]
    v_add_u32 v11, 45056, v18
    v_xor_b32 v12, 64, v11
    ds_read_b64_tr_b16 v[96:97], v11
    ds_read_b64_tr_b16 v[98:99], v11 offset:1024
    ds_read_b64_tr_b16 v[100:101], v12
    ds_read_b64_tr_b16 v[102:103], v12 offset:1024
    s_add_u32 m0, s22, 0
    s_add_u32 s3, s100, 0
    buffer_load_dwordx4 v6, s[44:47], s3 offen lds
    s_add_u32 m0, s22, 1024
    s_add_u32 s3, s100, 7168
    buffer_load_dwordx4 v6, s[44:47], s3 offen lds
    s_add_u32 s100, s100, s101
    s_cmp_eq_u32 s14, 2
    s_cbranch_scc0 L_O41
    s_setprio 3
    s_waitcnt vmcnt(6)
    v_mov_b32 v3, 163788
    v_mov_b32 v4, 1
    s_mov_b64 exec, 1
    ds_add_rtn_u32 v5, v3, v4
    s_mov_b64 exec, -1
    s_waitcnt lgkmcnt(0)
    v_readfirstlane_b32 s3, v5
    s_nop 1
    s_cmp_lg_u32 s3, 7
    s_nop 0
    s_cbranch_scc1 L_SG42
    v_mov_b32 v4, 1
    s_mov_b64 exec, 1
    buffer_store_dword v4, v23, s[48:51], s11 offen offset:128 sc1
    s_mov_b64 exec, -1
L_SG42:
    s_setprio 2
L_O41:
    v_mov_b32 v3, 163812
    s_cmp_lg_u32 s68, 0
    s_cbranch_scc1 L_PO43
    s_waitcnt vmcnt(12)
    s_mov_b32 s85, 0
L_PC45:
    v_cmp_eq_u32 vcc, 1, v249
    s_nop 1
    s_and_b32 s3, vcc_lo, 65280
    s_cmp_eq_u32 s3, 65280
    s_cbranch_scc1 L_PD46
    s_add_u32 s85, s85, 1
    s_cmp_gt_u32 s85, 200000
    s_cbranch_scc1 L_PD46
    s_sleep 4
    s_mov_b64 exec, 65280
    buffer_load_dword v249, v19, s[48:51], s13 offen offset:128 sc1
    s_mov_b64 exec, -1
    s_waitcnt vmcnt(0)
    s_branch L_PC45
L_PD46:
    v_mov_b32 v4, 1
    ds_write_b32 v3, v4
    s_waitcnt lgkmcnt(0)
    s_branch L_PJ44
L_PO43:
    s_mov_b32 s85, 0
L_PO43_l:
    ds_read_b32 v4, v3
    s_waitcnt lgkmcnt(0)
    v_readfirstlane_b32 s3, v4
    s_nop 1
    s_cmp_lg_u32 s3, 0
    s_nop 0
    s_cbranch_scc1 L_PJ44
    s_add_u32 s85, s85, 1
    s_cmp_gt_u32 s85, 3200000
    s_cbranch_scc1 L_PJ44
    s_sleep 1
    s_branch L_PO43_l
L_PJ44:
    s_setprio 1
    s_cmp_lg_u32 s68, 0
    s_cbranch_scc1 L_PI47
    s_mov_b64 exec, 65280
    buffer_load_dword v250, v19, s[48:51], s13 offen offset:256 sc1
    s_mov_b64 exec, -1
L_PI47:
    s_add_u32 s3, s95, 32768
    buffer_load_dwordx4 v[160:163], v13, s[48:51], s3 offen sc1
    s_add_u32 s3, s95, 32768
    buffer_load_dwordx4 v[164:167], v9, s[48:51], s3 offen sc1
    s_waitcnt vmcnt(6)
    v_mfma_f32_32x32x16_bf16 v[24:39], v[104:107], v[144:147], v[24:39]
    v_mfma_f32_32x32x16_bf16 v[40:55], v[108:111], v[144:147], v[40:55]
    v_mfma_f32_32x32x16_bf16 v[56:71], v[104:107], v[148:151], v[56:71]
    v_mfma_f32_32x32x16_bf16 v[72:87], v[108:111], v[148:151], v[72:87]
    v_add_u32 v11, 61440, v18
    v_xor_b32 v12, 64, v11
    ds_read_b64_tr_b16 v[104:105], v11
    ds_read_b64_tr_b16 v[106:107], v11 offset:1024
    ds_read_b64_tr_b16 v[108:109], v12
    ds_read_b64_tr_b16 v[110:111], v12 offset:1024
    s_add_u32 s3, s95, 40960
    buffer_load_dwordx4 v[168:171], v13, s[48:51], s3 offen sc1
    s_add_u32 s3, s95, 40960
    buffer_load_dwordx4 v[172:175], v9, s[48:51], s3 offen sc1
    s_waitcnt vmcnt(6)
    v_mfma_f32_32x32x16_bf16 v[24:39], v[112:115], v[152:155], v[24:39]
    v_mfma_f32_32x32x16_bf16 v[40:55], v[116:119], v[152:155], v[40:55]
    v_mfma_f32_32x32x16_bf16 v[56:71], v[112:115], v[156:159], v[56:71]
    v_mfma_f32_32x32x16_bf16 v[72:87], v[116:119], v[156:159], v[72:87]
    v_add_u32 v11, 77824, v18
    v_xor_b32 v12, 64, v11
    ds_read_b64_tr_b16 v[112:113], v11
    ds_read_b64_tr_b16 v[114:115], v11 offset:1024
    ds_read_b64_tr_b16 v[116:117], v12
    ds_read_b64_tr_b16 v[118:119], v12 offset:1024
    s_add_u32 s3, s95, 49152
    buffer_load_dwordx4 v[176:179], v13, s[48:51], s3 offen sc1
    s_add_u32 s3, s95, 49152
    buffer_load_dwordx4 v[180:183], v9, s[48:51], s3 offen sc1
    s_add_u32 s3, s95, 57344
    buffer_load_dwordx4 v[184:187], v13, s[48:51], s3 offen sc1
    s_add_u32 s3, s95, 57344
    buffer_load_dwordx4 v[188:191], v9, s[48:51], s3 offen sc1
    s_waitcnt vmcnt(6)
    v_mfma_f32_32x32x16_bf16 v[24:39], v[120:123], v[160:163], v[24:39]
    v_mfma_f32_32x32x16_bf16 v[40:55], v[124:127], v[160:163], v[40:55]
    v_mfma_f32_32x32x16_bf16 v[56:71], v[120:123], v[164:167], v[56:71]
    v_mfma_f32_32x32x16_bf16 v[72:87], v[124:127], v[164:167], v[72:87]
    v_add_u32 v11, 94208, v18
    v_xor_b32 v12, 64, v11
    ds_read_b64_tr_b16 v[120:121], v11
    ds_read_b64_tr_b16 v[122:123], v11 offset:1024
    ds_read_b64_tr_b16 v[124:125], v12
    ds_read_b64_tr_b16 v[126:127], v12 offset:1024
    v_mov_b32 v3, 163816
    s_cmp_lg_u32 s68, 0
    s_nop 2
    s_cbranch_scc1 L_PO48
    s_waitcnt vmcnt(8)
    s_mov_b32 s85, 0
L_PC50:
    v_cmp_eq_u32 vcc, 1, v250
    s_nop 1
    s_and_b32 s3, vcc_lo, 65280
    s_cmp_eq_u32 s3, 65280
    s_cbranch_scc1 L_PD51
    s_add_u32 s85, s85, 1
    s_cmp_gt_u32 s85, 200000
    s_cbranch_scc1 L_PD51
    s_sleep 4
    s_mov_b64 exec, 65280
    buffer_load_dword v250, v19, s[48:51], s13 offen offset:256 sc1
    s_mov_b64 exec, -1
    s_waitcnt vmcnt(0)
    s_branch L_PC50
L_PD51:
    v_mov_b32 v4, 1
    ds_write_b32 v3, v4
    s_waitcnt lgkmcnt(0)
    s_branch L_PJ49
L_PO48:
    s_mov_b32 s85, 0
L_PO48_l:
    ds_read_b32 v4, v3
    s_waitcnt lgkmcnt(0)
    v_readfirstlane_b32 s3, v4
    s_nop 1
    s_cmp_lg_u32 s3, 0
    s_nop 0
    s_cbranch_scc1 L_PJ49
    s_add_u32 s85, s85, 1
    s_cmp_gt_u32 s85, 3200000
    s_cbranch_scc1 L_PJ49
    s_sleep 1
    s_branch L_PO48_l
L_PJ49:
    s_cmp_eq_u32 s75, 0
    s_cbranch_scc0 L_C52
    s_setprio 0
L_C52:
    s_add_u32 m0, s22, 28672
    s_add_u32 s3, s100, 0
    buffer_load_dwordx4 v6, s[44:47], s3 offen lds
    s_add_u32 m0, s22, 29696
    s_add_u32 s3, s100, 7168
    buffer_load_dwordx4 v6, s[44:47], s3 offen lds
    s_add_u32 s100, s100, s101
    s_waitcnt vmcnt(6)
    v_mfma_f32_32x32x16_bf16 v[24:39], v[224:227], v[168:171], v[24:39]
    v_mfma_f32_32x32x16_bf16 v[40:55], v[228:231], v[168:171], v[40:55]
    v_mfma_f32_32x32x16_bf16 v[56:71], v[224:227], v[172:175], v[56:71]
    v_mfma_f32_32x32x16_bf16 v[72:87], v[228:231], v[172:175], v[72:87]
    v_add_u32 v11, 114688, v18
    v_xor_b32 v12, 64, v11
    ds_read_b64_tr_b16 v[224:225], v11
    ds_read_b64_tr_b16 v[226:227], v11 offset:1024
    ds_read_b64_tr_b16 v[228:229], v12
    ds_read_b64_tr_b16 v[230:231], v12 offset:1024
    s_add_u32 s3, s95, 65536
    buffer_load_dwordx4 v[192:195], v13, s[48:51], s3 offen sc1
    s_add_u32 s3, s95, 65536
    buffer_load_dwordx4 v[196:199], v9, s[48:51], s3 offen sc1
    s_waitcnt vmcnt(6)
    v_mfma_f32_32x32x16_bf16 v[24:39], v[232:235], v[176:179], v[24:39]
    v_mfma_f32_32x32x16_bf16 v[40:55], v[236:239], v[176:179], v[40:55]
    v_mfma_f32_32x32x16_bf16 v[56:71], v[232:235], v[180:183], v[56:71]
    v_mfma_f32_32x32x16_bf16 v[72:87], v[236:239], v[180:183], v[72:87]
    v_add_u32 v11, 131072, v18
    v_xor_b32 v12, 64, v11
    ds_read_b64_tr_b16 v[232:233], v11
    ds_read_b64_tr_b16 v[234:235], v11 offset:1024
    ds_read_b64_tr_b16 v[236:237], v12
    ds_read_b64_tr_b16 v[238:239], v12 offset:1024
    s_add_u32 s3, s95, 73728
    buffer_load_dwordx4 v[200:203], v13, s[48:51], s3 offen sc1
    s_add_u32 s3, s95, 73728
    buffer_load_dwordx4 v[204:207], v9, s[48:51], s3 offen sc1
    s_waitcnt vmcnt(6)
    v_mfma_f32_32x32x16_bf16 v[24:39], v[240:243], v[184:187], v[24:39]
    v_mfma_f32_32x32x16_bf16 v[40:55], v[244:247], v[184:187], v[40:55]
    v_mfma_f32_32x32x16_bf16 v[56:71], v[240:243], v[188:191], v[56:71]
    v_mfma_f32_32x32x16_bf16 v[72:87], v[244:247], v[188:191], v[72:87]
    v_add_u32 v11, 0, v18
    v_xor_b32 v12, 64, v11
    ds_read_b64_tr_b16 v[240:241], v11
    ds_read_b64_tr_b16 v[242:243], v11 offset:1024
    ds_read_b64_tr_b16 v[244:245], v12
    ds_read_b64_tr_b16 v[246:247], v12 offset:1024
    s_cmp_lg_u32 s68, 4
    s_nop 3
    s_cbranch_scc1 L_PI53
    s_mov_b64 exec, 255
    buffer_load_dword v249, v19, s[48:51], s13 offen offset:128 sc1
    s_mov_b64 exec, -1
L_PI53:
    s_add_u32 m0, s22, 45056
    s_add_u32 s3, s100, 0
    buffer_load_dwordx4 v6, s[44:47], s3 offen lds
    s_add_u32 m0, s22, 46080
    s_add_u32 s3, s100, 7168
    buffer_load_dwordx4 v6, s[44:47], s3 offen lds
    s_add_u32 s100, s100, s101
    s_add_u32 s3, s95, 81920
    buffer_load_dwordx4 v[208:211], v13, s[48:51], s3 offen sc1
    s_add_u32 s3, s95, 81920
    buffer_load_dwordx4 v[212:215], v9, s[48:51], s3 offen sc1
    s_waitcnt vmcnt(6)
    v_mfma_f32_32x32x16_bf16 v[24:39], v[88:91], v[192:195], v[24:39]
    v_mfma_f32_32x32x16_bf16 v[40:55], v[92:95], v[192:195], v[40:55]
    v_mfma_f32_32x32x16_bf16 v[56:71], v[88:91], v[196:199], v[56:71]
    v_mfma_f32_32x32x16_bf16 v[72:87], v[92:95], v[196:199], v[72:87]
    v_add_u32 v11, 28672, v18
    v_xor_b32 v12, 64, v11
    s_waitcnt lgkmcnt(8)
    ds_read_b64_tr_b16 v[88:89], v11
    ds_read_b64_tr_b16 v[90:91], v11 offset:1024
    ds_read_b64_tr_b16 v[92:93], v12
    ds_read_b64_tr_b16 v[94:95], v12 offset:1024
    s_add_u32 s3, s95, 90112
    buffer_load_dwordx4 v[216:219], v13, s[48:51], s3 offen sc1
    s_add_u32 s3, s95, 90112
    buffer_load_dwordx4 v[220:223], v9, s[48:51], s3 offen sc1
    s_waitcnt vmcnt(6)
    v_mfma_f32_32x32x16_bf16 v[24:39], v[96:99], v[200:203], v[24:39]
    v_mfma_f32_32x32x16_bf16 v[40:55], v[100:103], v[200:203], v[40:55]
    v_mfma_f32_32x32x16_bf16 v[56:71], v[96:99], v[204:207], v[56:71]
    v_mfma_f32_32x32x16_bf16 v[72:87], v[100:103], v[204:207], v[72:87]
    s_cmp_lg_u32 s68, 0
    s_nop 9
    s_cbranch_scc1 L_PI54
    s_mov_b64 exec, 8704
    buffer_load_dword v251, v19, s[48:51], s13 offen offset:384 sc1
    s_mov_b64 exec, -1
L_PI54:
    v_mov_b32 v3, 163820
    s_cmp_lg_u32 s68, 4
    s_cbranch_scc1 L_PO55
    s_waitcnt vmcnt(6)
    s_mov_b32 s85, 0
L_PC57:
    v_cmp_eq_u32 vcc, 1, v249
    s_nop 1
    s_and_b32 s3, vcc_lo, 255
    s_cmp_eq_u32 s3, 255
    s_cbranch_scc1 L_PD58
    s_add_u32 s85, s85, 1
    s_cmp_gt_u32 s85, 200000
    s_cbranch_scc1 L_PD58
    s_sleep 4
    s_mov_b64 exec, 255
    buffer_load_dword v249, v19, s[48:51], s13 offen offset:128 sc1
    s_mov_b64 exec, -1
    s_waitcnt vmcnt(0)
    s_branch L_PC57
L_PD58:
    v_mov_b32 v4, 1
    ds_write_b32 v3, v4
    s_waitcnt lgkmcnt(0)
    s_branch L_PJ56
L_PO55:
    s_mov_b32 s85, 0
L_PO55_l:
    ds_read_b32 v4, v3
    s_waitcnt lgkmcnt(0)
    v_readfirstlane_b32 s3, v4
    s_nop 1
    s_cmp_lg_u32 s3, 0
    s_nop 0
    s_cbranch_scc1 L_PJ56
    s_add_u32 s85, s85, 1
    s_cmp_gt_u32 s85, 3200000
    s_cbranch_scc1 L_PJ56
    s_sleep 1
    s_branch L_PO55_l
L_PJ56:
    s_add_u32 s3, s95, 114688
    buffer_load_dwordx4 v[128:131], v13, s[48:51], s3 offen sc1
    s_add_u32 s3, s95, 114688
    buffer_load_dwordx4 v[132:135], v9, s[48:51], s3 offen sc1
    s_waitcnt vmcnt(6)
    v_add_u32 v11, 45056, v18
    v_xor_b32 v12, 64, v11
    ds_read_b64_tr_b16 v[96:97], v11
    ds_read_b64_tr_b16 v[98:99], v11 offset:1024
    ds_read_b64_tr_b16 v[100:101], v12
    ds_read_b64_tr_b16 v[102:103], v12 offset:1024
    s_cmp_lg_u32 s68, 0
    s_cbranch_scc1 L_PI59
    s_mov_b64 exec, 34
    buffer_load_dword v251, v19, s[48:51], s13 offen offset:384 sc1
    s_mov_b64 exec, -1
L_PI59:
    s_add_u32 s3, s95, 122880
    buffer_load_dwordx4 v[136:139], v13, s[48:51], s3 offen sc1
    s_add_u32 s3, s95, 122880
    buffer_load_dwordx4 v[140:143], v9, s[48:51], s3 offen sc1
    s_waitcnt vmcnt(6)
    v_mfma_f32_32x32x16_bf16 v[24:39], v[104:107], v[208:211], v[24:39]
    v_mfma_f32_32x32x16_bf16 v[40:55], v[108:111], v[208:211], v[40:55]
    v_mfma_f32_32x32x16_bf16 v[56:71], v[104:107], v[212:215], v[56:71]
    v_mfma_f32_32x32x16_bf16 v[72:87], v[108:111], v[212:215], v[72:87]
    s_cmp_eq_u32 s75, 0
    s_nop 9
    s_cbranch_scc0 L_C60
    v_mov_b32 v3, 163824
    s_cmp_lg_u32 s68, 0
    s_cbranch_scc1 L_PO61
    s_waitcnt vmcnt(4)
    s_mov_b32 s85, 0
L_PC63:
    v_cmp_eq_u32 vcc, 1, v251
    s_nop 1
    s_and_b32 s3, vcc_lo, 8704
    s_cmp_eq_u32 s3, 8704
    s_cbranch_scc1 L_PD64
    s_add_u32 s85, s85, 1
    s_cmp_gt_u32 s85, 200000
    s_cbranch_scc1 L_PD64
    s_sleep 4
    s_mov_b64 exec, 8704
    buffer_load_dword v251, v19, s[48:51], s13 offen offset:384 sc1
    s_mov_b64 exec, -1
    s_waitcnt vmcnt(0)
    s_branch L_PC63
L_PD64:
    v_mov_b32 v4, 1
    ds_write_b32 v3, v4
    s_waitcnt lgkmcnt(0)
    s_branch L_PJ62
L_PO61:
    s_mov_b32 s85, 0
L_PO61_l:
    ds_read_b32 v4, v3
    s_waitcnt lgkmcnt(0)
    v_readfirstlane_b32 s3, v4
    s_nop 1
    s_cmp_lg_u32 s3, 0
    s_nop 0
    s_cbranch_scc1 L_PJ62
    s_add_u32 s85, s85, 1
    s_cmp_gt_u32 s85, 3200000
    s_cbranch_scc1 L_PJ62
    s_sleep 1
    s_branch L_PO61_l
L_PJ62:
L_C60:
    s_add_u32 s3, s82, 98304
    buffer_load_dwordx4 v[144:147], v13, s[48:51], s3 offen sc1
    s_add_u32 s3, s82, 98304
    buffer_load_dwordx4 v[148:151], v9, s[48:51], s3 offen sc1
    s_waitcnt vmcnt(6)
    v_mfma_f32_32x32x16_bf16 v[24:39], v[112:115], v[216:219], v[24:39]
    v_mfma_f32_32x32x16_bf16 v[40:55], v[116:119], v[216:219], v[40:55]
    v_mfma_f32_32x32x16_bf16 v[56:71], v[112:115], v[220:223], v[56:71]
    v_mfma_f32_32x32x16_bf16 v[72:87], v[116:119], v[220:223], v[72:87]
    s_add_u32 s3, s82, 102400
    buffer_load_dwordx4 v[152:155], v13, s[48:51], s3 offen sc1
    s_add_u32 s3, s82, 102400
    buffer_load_dwordx4 v[156:159], v9, s[48:51], s3 offen sc1
    s_waitcnt vmcnt(6)
    v_mfma_f32_32x32x16_bf16 v[24:39], v[120:123], v[128:131], v[24:39]
    v_mfma_f32_32x32x16_bf16 v[40:55], v[124:127], v[128:131], v[40:55]
    v_mfma_f32_32x32x16_bf16 v[56:71], v[120:123], v[132:135], v[56:71]
    v_mfma_f32_32x32x16_bf16 v[72:87], v[124:127], v[132:135], v[72:87]
    s_cmp_eq_u32 s75, 0
    s_nop 9
    s_cbranch_scc0 L_C65
    v_mov_b32 v3, 163828
    s_cmp_lg_u32 s68, 0
    s_cbranch_scc1 L_PO66
    s_waitcnt vmcnt(6)
    s_mov_b32 s85, 0
L_PC68:
    v_cmp_eq_u32 vcc, 1, v251
    s_nop 1
    s_and_b32 s3, vcc_lo, 34
    s_cmp_eq_u32 s3, 34
    s_cbranch_scc1 L_PD69
    s_add_u32 s85, s85, 1
    s_cmp_gt_u32 s85, 200000
    s_cbranch_scc1 L_PD69
    s_sleep 4
    s_mov_b64 exec, 34
    buffer_load_dword v251, v19, s[48:51], s13 offen offset:384 sc1
    s_mov_b64 exec, -1
    s_waitcnt vmcnt(0)
    s_branch L_PC68
L_PD69:
    v_mov_b32 v4, 1
    ds_write_b32 v3, v4
    s_waitcnt lgkmcnt(0)
    s_branch L_PJ67
L_PO66:
    s_mov_b32 s85, 0
L_PO66_l:
    ds_read_b32 v4, v3
    s_waitcnt lgkmcnt(0)
    v_readfirstlane_b32 s3, v4
    s_nop 1
    s_cmp_lg_u32 s3, 0
    s_nop 0
    s_cbranch_scc1 L_PJ67
    s_add_u32 s85, s85, 1
    s_cmp_gt_u32 s85, 3200000
    s_cbranch_scc1 L_PJ67
    s_sleep 1
    s_branch L_PO66_l
L_PJ67:
L_C65:
    s_mov_b64 s[64:65], s[30:31]
    s_mov_b32 s66, 896
    s_mov_b32 s67, 0x20000
    v_lshrrev_b32 v2, 3, v1
    v_and_b32 v3, 7, v1
    v_mul_u32_u24 v7, 896, v2
    v_lshl_add_u32 v7, v3, 4, v7
    s_lshl_b32 s3, s92, 3
    s_add_u32 s3, s3, s83
    s_mul_i32 s3, s3, 7168
    s_lshl_b32 s73, s91, 7
    s_add_u32 s3, s3, s73
    v_add_u32 v7, s3, v7
    v_lshlrev_b32 v4, 4, v3
    buffer_load_dwordx4 v[248:251], v7, s[40:43], 0 offen
    buffer_load_dwordx4 v[252:255], v4, s[64:67], s73 offen
    s_cmp_lt_u32 s83, 4
    s_mov_b32 s3, 94208
    s_cselect_b32 s3, 28672, s3
    v_mov_b32 v16, s3
    s_mov_b32 s3, 114688
    s_cselect_b32 s3, 45056, s3
    v_mov_b32 v4, s3
    v_cmp_lt_u32 vcc, 1, v3
    s_nop 1
    v_cndmask_b32 v16, v16, v4, vcc
    s_mov_b32 s3, 131072
    s_cselect_b32 s3, 61440, s3
    v_mov_b32 v4, s3
    v_cmp_lt_u32 vcc, 3, v3
    s_nop 1
    v_cndmask_b32 v16, v16, v4, vcc
    s_cselect_b32 s3, 77824, 0
    v_mov_b32 v4, s3
    v_cmp_lt_u32 vcc, 5, v3
    s_nop 1
    v_cndmask_b32 v16, v16, v4, vcc
    v_add_u32 v19, s22, v13
    v_and_b32 v4, 1, v3
    v_lshl_add_u32 v16, v4, 10, v16
    s_and_b32 s3, s83, 3
    s_lshl_b32 s3, s3, 3
    v_add_u32 v2, s3, v2
    v_lshlrev_b32 v3, 1, v3
    v_xor_b32 v2, v2, v3
    v_lshl_add_u32 v16, v2, 4, v16
    s_waitcnt vmcnt(6)
    v_mfma_f32_32x32x16_bf16 v[24:39], v[224:227], v[136:139], v[24:39]
    v_mfma_f32_32x32x16_bf16 v[40:55], v[228:231], v[136:139], v[40:55]
    v_mfma_f32_32x32x16_bf16 v[56:71], v[224:227], v[140:143], v[56:71]
    v_mfma_f32_32x32x16_bf16 v[72:87], v[228:231], v[140:143], v[72:87]
    s_add_u32 s3, s82, 106496
    buffer_load_dwordx4 v[160:163], v13, s[48:51], s3 offen sc1
    s_add_u32 s3, s82, 106496
    buffer_load_dwordx4 v[164:167], v9, s[48:51], s3 offen sc1
    s_waitcnt vmcnt(6)
    v_mfma_f32_32x32x16_bf16 v[24:39], v[232:235], v[144:147], v[24:39]
    v_mfma_f32_32x32x16_bf16 v[40:55], v[236:239], v[144:147], v[40:55]
    v_mfma_f32_32x32x16_bf16 v[56:71], v[232:235], v[148:151], v[56:71]
    v_mfma_f32_32x32x16_bf16 v[72:87], v[236:239], v[148:151], v[72:87]
    s_add_u32 s3, s82, 110592
    buffer_load_dwordx4 v[168:171], v13, s[48:51], s3 offen sc1
    s_add_u32 s3, s82, 110592
    buffer_load_dwordx4 v[172:175], v9, s[48:51], s3 offen sc1
    s_waitcnt vmcnt(6)
    v_mfma_f32_32x32x16_bf16 v[24:39], v[240:243], v[152:155], v[24:39]
    v_mfma_f32_32x32x16_bf16 v[40:55], v[244:247], v[152:155], v[40:55]
    v_mfma_f32_32x32x16_bf16 v[56:71], v[240:243], v[156:159], v[56:71]
    v_mfma_f32_32x32x16_bf16 v[72:87], v[244:247], v[156:159], v[72:87]
    s_waitcnt vmcnt(2)
    v_mfma_f32_32x32x16_bf16 v[24:39], v[88:91], v[160:163], v[24:39]
    v_mfma_f32_32x32x16_bf16 v[40:55], v[92:95], v[160:163], v[40:55]
    v_mfma_f32_32x32x16_bf16 v[56:71], v[88:91], v[164:167], v[56:71]
    v_mfma_f32_32x32x16_bf16 v[72:87], v[92:95], v[164:167], v[72:87]
    s_waitcnt vmcnt(0)
    s_waitcnt lgkmcnt(0)
    v_mfma_f32_32x32x16_bf16 v[24:39], v[96:99], v[168:171], v[24:39]
    v_mfma_f32_32x32x16_bf16 v[40:55], v[100:103], v[168:171], v[40:55]
    v_mfma_f32_32x32x16_bf16 v[56:71], v[96:99], v[172:175], v[56:71]
    v_mfma_f32_32x32x16_bf16 v[72:87], v[100:103], v[172:175], v[72:87]
    v_xor_b32 v2, 0, v19
    v_add_u32 v2, 28672, v2
    s_nop 6
    ds_write_b128 v2, v[24:27] offset:0
    v_xor_b32 v3, 32, v19
    v_add_u32 v3, 28672, v3
    ds_write_b128 v3, v[28:31] offset:1024
    v_xor_b32 v2, 64, v19
    v_add_u32 v2, 45056, v2
    ds_write_b128 v2, v[32:35] offset:0
    v_xor_b32 v3, 96, v19
    v_add_u32 v3, 45056, v3
    ds_write_b128 v3, v[36:39] offset:1024
    v_xor_b32 v2, 128, v19
    v_add_u32 v2, 61440, v2
    ds_write_b128 v2, v[40:43] offset:0
    v_xor_b32 v3, 160, v19
    v_add_u32 v3, 61440, v3
    ds_write_b128 v3, v[44:47] offset:1024
    v_xor_b32 v2, 192, v19
    v_add_u32 v2, 77824, v2
    ds_write_b128 v2, v[48:51] offset:0
    v_xor_b32 v3, 224, v19
    v_add_u32 v3, 77824, v3
    ds_write_b128 v3, v[52:55] offset:1024
    v_xor_b32 v2, 0, v19
    v_add_u32 v2, 94208, v2
    ds_write_b128 v2, v[56:59] offset:0
    v_xor_b32 v3, 32, v19
    v_add_u32 v3, 94208, v3
    ds_write_b128 v3, v[60:63] offset:1024
    v_xor_b32 v2, 64, v19
    v_add_u32 v2, 114688, v2
    ds_write_b128 v2, v[64:67] offset:0
    v_xor_b32 v3, 96, v19
    v_add_u32 v3, 114688, v3
    ds_write_b128 v3, v[68:71] offset:1024
    v_xor_b32 v2, 128, v19
    v_add_u32 v2, 131072, v2
    ds_write_b128 v2, v[72:75] offset:0
    v_xor_b32 v3, 160, v19
    v_add_u32 v3, 131072, v3
    ds_write_b128 v3, v[76:79] offset:1024
    v_xor_b32 v2, 192, v19
    v_add_u32 v2, 0, v2
    ds_write_b128 v2, v[80:83] offset:0
    v_xor_b32 v3, 224, v19
    v_add_u32 v3, 0, v3
    ds_write_b128 v3, v[84:87] offset:1024
    s_mov_b64 s[64:65], s[32:33]
    s_mov_b32 s66, 1835008
    s_mov_b32 s67, 0x20000
    v_lshlrev_b32 v128, 16, v248
    v_and_b32 v129, s77, v248
    v_lshlrev_b32 v130, 16, v249
    v_and_b32 v131, s77, v249
    v_lshlrev_b32 v132, 16, v250
    v_and_b32 v133, s77, v250
    v_lshlrev_b32 v134, 16, v251
    v_and_b32 v135, s77, v251
    v_lshlrev_b32 v136, 16, v252
    v_and_b32 v137, s77, v252
    v_lshlrev_b32 v138, 16, v253
    v_and_b32 v139, s77, v253
    v_lshlrev_b32 v140, 16, v254
    v_and_b32 v141, s77, v254
    v_lshlrev_b32 v142, 16, v255
    v_and_b32 v143, s77, v255
    v_add_f32 v128, v128, v136
    v_add_f32 v129, v129, v137
    v_add_f32 v130, v130, v138
    v_add_f32 v131, v131, v139
    v_add_f32 v132, v132, v140
    v_add_f32 v133, v133, v141
    v_add_f32 v134, v134, v142
    v_add_f32 v135, v135, v143
    s_waitcnt lgkmcnt(0)
    s_barrier
    ds_read_b128 v[144:147], v16 offset:0
    ds_read_b128 v[148:151], v16 offset:512
    ds_read_b128 v[152:155], v16 offset:2048
    ds_read_b128 v[156:159], v16 offset:2560
    ds_read_b128 v[160:163], v16 offset:4096
    ds_read_b128 v[164:167], v16 offset:4608
    ds_read_b128 v[168:171], v16 offset:6144
    ds_read_b128 v[172:175], v16 offset:6656
    ds_read_b128 v[176:179], v16 offset:8192
    ds_read_b128 v[180:183], v16 offset:8704
    ds_read_b128 v[184:187], v16 offset:10240
    ds_read_b128 v[188:191], v16 offset:10752
    s_waitcnt lgkmcnt(4)
    ds_read_b128 v[192:195], v16 offset:12288
    ds_read_b128 v[196:199], v16 offset:12800
    ds_read_b128 v[200:203], v16 offset:14336
    ds_read_b128 v[204:207], v16 offset:14848
    v_add_f32 v144, v144, v152
    v_add_f32 v145, v145, v153
    v_add_f32 v146, v146, v154
    v_add_f32 v147, v147, v155
    v_add_f32 v148, v148, v156
    v_add_f32 v149, v149, v157
    v_add_f32 v150, v150, v158
    v_add_f32 v151, v151, v159
    v_add_f32 v160, v160, v168
    v_add_f32 v161, v161, v169
    v_add_f32 v162, v162, v170
    v_add_f32 v163, v163, v171
    v_add_f32 v164, v164, v172
    v_add_f32 v165, v165, v173
    v_add_f32 v166, v166, v174
    v_add_f32 v167, v167, v175
    v_add_f32 v144, v144, v160
    v_add_f32 v145, v145, v161
    v_add_f32 v146, v146, v162
    v_add_f32 v147, v147, v163
    v_add_f32 v148, v148, v164
    v_add_f32 v149, v149, v165
    v_add_f32 v150, v150, v166
    v_add_f32 v151, v151, v167
    s_waitcnt lgkmcnt(0)
    v_add_f32 v176, v176, v184
    v_add_f32 v177, v177, v185
    v_add_f32 v178, v178, v186
    v_add_f32 v179, v179, v187
    v_add_f32 v180, v180, v188
    v_add_f32 v181, v181, v189
    v_add_f32 v182, v182, v190
    v_add_f32 v183, v183, v191
    v_add_f32 v192, v192, v200
    v_add_f32 v193, v193, v201
    v_add_f32 v194, v194, v202
    v_add_f32 v195, v195, v203
    v_add_f32 v196, v196, v204
    v_add_f32 v197, v197, v205
    v_add_f32 v198, v198, v206
    v_add_f32 v199, v199, v207
    v_add_f32 v176, v176, v192
    v_add_f32 v177, v177, v193
    v_add_f32 v178, v178, v194
    v_add_f32 v179, v179, v195
    v_add_f32 v180, v180, v196
    v_add_f32 v181, v181, v197
    v_add_f32 v182, v182, v198
    v_add_f32 v183, v183, v199
    v_add_f32 v144, v144, v176
    v_add_f32 v145, v145, v177
    v_add_f32 v146, v146, v178
    v_add_f32 v147, v147, v179
    v_add_f32 v148, v148, v180
    v_add_f32 v149, v149, v181
    v_add_f32 v150, v150, v182
    v_add_f32 v151, v151, v183
    v_add_f32 v144, v144, v128
    v_add_f32 v145, v145, v129
    v_add_f32 v146, v146, v130
    v_add_f32 v147, v147, v131
    v_add_f32 v148, v148, v132
    v_add_f32 v149, v149, v133
    v_add_f32 v150, v150, v134
    v_add_f32 v151, v151, v135
    v_cvt_pk_bf16_f32 v128, v144, v145
    v_cvt_pk_bf16_f32 v129, v146, v147
    v_cvt_pk_bf16_f32 v130, v148, v149
    v_cvt_pk_bf16_f32 v131, v150, v151
    buffer_store_dwordx4 v[128:131], v7, s[64:67], 0 offen sc1
L_END:
L_EXIT:
    s_endpgm
OST_LOAD:
    v_mov_b32 v3, 163832
    s_cmp_lg_u32 s68, 0
    s_cbranch_scc1 L_PO70
    s_mov_b32 s85, 0
L_PC72:
    v_cmp_eq_u32 vcc, 1, v17
    s_nop 1
    s_and_b32 s3, vcc_lo, 65535
    s_cmp_eq_u32 s3, 65535
    s_cbranch_scc1 L_PD73
    s_add_u32 s85, s85, 1
    s_cmp_gt_u32 s85, 200000
    s_cbranch_scc1 L_PD73
    s_sleep 4
    v_lshlrev_b32 v2, 13, v1
    s_mov_b64 exec, 65535
    buffer_load_dword v17, v2, s[48:51], s12 offen sc1
    s_mov_b64 exec, -1
    s_waitcnt vmcnt(0)
    s_branch L_PC72
L_PD73:
    v_mov_b32 v4, 1
    ds_write_b32 v3, v4
    s_waitcnt lgkmcnt(0)
    s_branch L_PJ71
L_PO70:
    s_mov_b32 s85, 0
L_PO70_l:
    ds_read_b32 v4, v3
    s_waitcnt lgkmcnt(0)
    v_readfirstlane_b32 s3, v4
    s_nop 1
    s_cmp_lg_u32 s3, 0
    s_nop 0
    s_cbranch_scc1 L_PJ71
    s_add_u32 s85, s85, 1
    s_cmp_gt_u32 s85, 3200000
    s_cbranch_scc1 L_PJ71
    s_sleep 1
    s_branch L_PO70_l
L_PJ71:
    s_lshl_b32 s3, s70, 3
    s_add_u32 s3, s3, s68
    s_lshl_b32 s3, s3, 10
    s_add_u32 s3, s3, 10485760
    buffer_load_dwordx4 v[176:179], v13, s[48:51], s3 offen sc1
    s_setpc_b64 s[96:97]
OST_COMP:
    s_lshl_b32 s3, s68, 10
    s_add_u32 s3, s3, 151552
    v_add_u32 v2, s3, v13
    ds_write_b128 v2, v[176:179]
    s_lshl_b32 s3, s75, 12
    s_add_u32 s3, s3, 151552
    v_lshlrev_b32 v2, 2, v1
    v_add_u32 v2, s3, v2
    s_waitcnt lgkmcnt(0)
    s_barrier
    ds_read2st64_b32 v[176:177], v2 offset0:0 offset1:1
    ds_read2st64_b32 v[178:179], v2 offset0:2 offset1:3
    ds_read2st64_b32 v[180:181], v2 offset0:4 offset1:5
    ds_read2st64_b32 v[182:183], v2 offset0:6 offset1:7
    ds_read2st64_b32 v[184:185], v2 offset0:8 offset1:9
    ds_read2st64_b32 v[186:187], v2 offset0:10 offset1:11
    ds_read2st64_b32 v[188:189], v2 offset0:12 offset1:13
    ds_read2st64_b32 v[190:191], v2 offset0:14 offset1:15
    s_waitcnt lgkmcnt(0)
    s_lshl_b32 s3, s84, 11
    s_add_u32 s3, s3, 114688
    s_add_u32 s80, s81, s3
    v_cvt_pk_bf16_f32 v192, v176, v177
    v_cvt_pk_bf16_f32 v193, v178, v179
    v_cvt_pk_bf16_f32 v194, v180, v181
    v_cvt_pk_bf16_f32 v195, v182, v183
    v_cvt_pk_bf16_f32 v196, v184, v185
    v_cvt_pk_bf16_f32 v197, v186, v187
    v_cvt_pk_bf16_f32 v198, v188, v189
    v_cvt_pk_bf16_f32 v199, v190, v191
    v_and_b32 v198, v20, v198
    v_and_b32 v199, v20, v199
    v_mfma_f32_32x32x16_bf16 v[40:55], v[192:195], v[24:27], 0
    s_nop 0
    v_mfma_f32_32x32x16_bf16 v[40:55], v[196:199], v[28:31], v[40:55]
    s_nop 11
    v_mov_b32 v3, v52
    v_mov_b32 v4, v52
    s_nop 1
    v_permlane32_swap_b32 v3, v4
    v_add_f32 v4, 0x358637bd, v4
    v_rcp_f32 v4, v4
    s_nop 0
    v_mul_f32 v40, v40, v4
    v_mul_f32 v41, v41, v4
    v_mul_f32 v42, v42, v4
    v_mul_f32 v43, v43, v4
    v_mul_f32 v44, v44, v4
    v_mul_f32 v45, v45, v4
    v_mul_f32 v46, v46, v4
    v_mul_f32 v47, v47, v4
    v_mul_f32 v48, v48, v4
    v_mul_f32 v49, v49, v4
    v_mul_f32 v50, v50, v4
    v_mul_f32 v51, v51, v4
    v_mul_f32 v52, v52, v4
    v_mul_f32 v53, v53, v4
    v_mul_f32 v54, v54, v4
    v_mul_f32 v55, v55, v4
    v_cvt_pk_bf16_f32 v32, v40, v41
    v_cvt_pk_bf16_f32 v33, v42, v43
    v_cvt_pk_bf16_f32 v34, v44, v45
    v_cvt_pk_bf16_f32 v35, v46, v47
    v_cvt_pk_bf16_f32 v36, v48, v49
    v_cvt_pk_bf16_f32 v37, v50, v51
    v_cvt_pk_bf16_f32 v38, v52, v53
    v_cvt_pk_bf16_f32 v39, v54, v55
    v_and_b32 v38, v20, v38
    v_and_b32 v39, v20, v39
    buffer_store_dwordx4 v[32:35], v13, s[48:51], s80 offen sc1
    buffer_store_dwordx4 v[36:39], v13, s[48:51], s80 offen offset:1024 sc1
    s_nop 0
    s_setpc_b64 s[96:97]
.fill 1024, 4, 0xbf800000
.section .rodata,"a"
.p2align 6
.amdhsa_kernel parallel_sum__linear_attn_block__mixer_channel_mlp__prompt_kernel
  .amdhsa_next_free_vgpr 256
  .amdhsa_next_free_sgpr 102
  .amdhsa_accum_offset 256
  .amdhsa_group_segment_fixed_size 0
  .amdhsa_kernarg_size 88
  .amdhsa_user_sgpr_count 2
  .amdhsa_user_sgpr_kernarg_segment_ptr 1
  .amdhsa_system_sgpr_workgroup_id_x 1
.end_amdhsa_kernel
```
